```python
import torch

def _softmax(x, axis=-1):
    return torch.softmax(x, dim=axis)

def _gelu(x):
    return torch.nn.functional.gelu(x, approximate='tanh')

def _silu(x):
    return torch.nn.functional.silu(x)

def _sigmoid(x):
    return torch.sigmoid(x)

def _layernorm(x, axis=-1, eps=1e-05):
    m = x.mean(dim=axis, keepdim=True)
    v = x.var(dim=axis, keepdim=True, unbiased=False)
    return (x - m) / torch.sqrt(v + eps)

def _scatter_add(tgt, idx, src, axis=0):
    return tgt.clone().index_add_(axis, idx, src)

def _segment_sum(src, seg, n):
    out = torch.zeros((n,) + src.shape[1:], dtype=src.dtype)
    return out.index_add_(0, seg, src)

def _pad(x, pw):
    flat = tuple((v for pair in reversed(pw) for v in pair))
    return torch.nn.functional.pad(x, flat)
kernel_name = 'adaLN_cond__ssm_conv_s4d__geglu_ffn__prompt'

def setup_inputs():

    _w = lambda a: (lambda t: t.to(torch.bfloat16) if t.is_floating_point() else t)(torch.as_tensor(a))

    def _A_setup():
        Bsz, L, D, N = (1, 2048, 640, 192)
        return {'u': _w((lambda *s: torch.randn(*s, dtype=torch.bfloat16) * 0.05)(Bsz, L, D)), 'log_A_real': _w((lambda *s: torch.randn(*s, dtype=torch.bfloat16) * 3.2)(D, N) * 0.5), 'A_imag': _w((lambda *s: torch.randn(*s, dtype=torch.bfloat16) * 0.1)(D, N) * 3.14), 'C_real': _w((lambda *s: torch.randn(*s, dtype=torch.bfloat16) * 0.4)(D, N) / N ** 0.5), 'C_imag': _w((lambda *s: torch.randn(*s, dtype=torch.bfloat16) * 0.4)(D, N) / N ** 0.5), 'log_dt': _w((lambda *s: torch.randn(*s, dtype=torch.bfloat16) * 0.1)(D) * 0.5 - 4.0), 'D_skip': _w((lambda *s: torch.randn(*s, dtype=torch.bfloat16) * 0.1)(D))}
    _A_in = _A_setup()

    def _B_setup():
        B, S, D, F = (1, 2048, 640, 1536)
        return {'x': _w((lambda *s: torch.randn(*s, dtype=torch.bfloat16) * 0.05)(B, S, D)), 'w_gate': _w((lambda *s: torch.randn(*s, dtype=torch.bfloat16) * 0.05)(D, F)), 'w_up': _w((lambda *s: torch.randn(*s, dtype=torch.bfloat16) * 0.05)(D, F)), 'w_down': _w((lambda *s: torch.randn(*s, dtype=torch.bfloat16) * 0.05)(F, D))}
    _B_in = _B_setup()
    return {'A_u': _A_in['u'], 'A_log_A_real': _A_in['log_A_real'], 'A_A_imag': _A_in['A_imag'], 'A_C_real': _A_in['C_real'], 'A_C_imag': _A_in['C_imag'], 'A_log_dt': _A_in['log_dt'], 'A_D_skip': _A_in['D_skip'], 'B_x': _B_in['x'], 'B_w_gate': _B_in['w_gate'], 'B_w_up': _B_in['w_up'], 'B_w_down': _B_in['w_down'], 'c': _w((lambda *s: torch.randn(*s, dtype=torch.bfloat16) * 0.2)(1, 640) * 8.0), 'w_mod': _w((lambda *s: torch.randn(*s, dtype=torch.bfloat16) * 0.2)(640, 6 * 640) * 640 ** (-0.5) * 8.0)}

def reference(A_u, A_log_A_real, A_A_imag, A_C_real, A_C_imag, A_log_dt, A_D_skip, B_x, B_w_gate, B_w_up, B_w_down, c, w_mod):

    def _A_ref(u, log_A_real, A_imag, C_real, C_imag, log_dt, D_skip):
        L = u.shape[1]
        dt = torch.exp(log_dt)
        A = -torch.exp(log_A_real) + 1j * A_imag
        C = (C_real + 1j * C_imag) * dt[:, None]
        pos = (lambda x, dt: x.to(dt))(torch.arange(L), log_dt.dtype)
        P = torch.exp((A * dt[:, None])[:, :, None] * pos[None, None, :])
        K = 2.0 * torch.einsum('dn,dnl->dl', C, P).real
        L2 = 2 * L
        u_t = (lambda x, *d: x.permute(*d))(u, 0, 2, 1)
        Kf = (lambda x, *a, **k: torch.fft.rfft(x.float(), *a, **k))(K, L2)
        Uf = (lambda x, *a, **k: torch.fft.rfft(x.float(), *a, **k))(u_t, L2)
        y = (lambda x, *a, **k: torch.fft.irfft(x, *a, **k).to(torch.bfloat16))(Uf * Kf[None, :, :], L2)[:, :, :L]
        y = (lambda x, *d: x.permute(*d))(y, 0, 2, 1)
        return y + u * D_skip[None, None, :]

    def _B_ref(x, w_gate, w_up, w_down):
        return _gelu(x @ w_gate) * (x @ w_up) @ w_down
    x = A_u
    mod = (_silu(c) @ w_mod).reshape(c.shape[0], 6, 1, -1)
    sa, ca, ga, sb, cb, gb = (mod[:, 0].clone(), mod[:, 1].clone(), mod[:, 2].clone(), mod[:, 3].clone(), mod[:, 4].clone(), mod[:, 5].clone())
    h = _layernorm(x, axis=-1) * (1 + ca) + sa
    x = x + ga * _A_ref(h, A_log_A_real, A_A_imag, A_C_real, A_C_imag, A_log_dt, A_D_skip)
    h = _layernorm(x, axis=-1) * (1 + cb) + sb
    x = x + gb * _B_ref(h, B_w_gate, B_w_up, B_w_down)
    return x
```

```asm
; @launch kernel=prep_kernel grid=(840,1,1) block=(256,1,1) lds=40960
; @launch kernel=conv_kernel grid=(808,1,1) block=(256,1,1) lds=40960
; @launch kernel=ffn_kernel grid=(256,1,1) block=(256,1,1) lds=156496
.amdgcn_target "amdgcn-amd-amdhsa--gfx950"
.text

.globl prep_kernel
.p2align 8
.type prep_kernel,@function
prep_kernel:
    s_cmp_lt_u32 s2, 640
    s_cbranch_scc1 L_k1_kg
    s_cmp_lt_u32 s2, 704
    s_cbranch_scc1 L_k1_ln
    s_cmp_lt_u32 s2, 824
    s_cbranch_scc1 L_k1_mod
    s_cmp_lt_u32 s2, 840
    s_cbranch_scc1 L_k1_pf
    s_endpgm
L_k1_kg:
    s_sub_u32 s3, s2, 0
    s_load_dwordx2 s[4:5], s[0:1], 8
    s_load_dwordx2 s[8:9], s[0:1], 16
    s_load_dwordx2 s[12:13], s[0:1], 24
    s_load_dwordx2 s[16:17], s[0:1], 32
    s_load_dwordx2 s[20:21], s[0:1], 40
    s_load_dwordx2 s[24:25], s[0:1], 120
    s_getpc_b64 s[28:29]
L_k1_pc:
    s_add_u32 s28, s28, ktable-L_k1_pc
    s_addc_u32 s29, s29, 0
    v_lshrrev_b32 v1, 6, v0
    v_and_b32 v2, 63, v0
    v_readfirstlane_b32 s30, v1
    v_lshlrev_b32 v3, 4, v0
    global_load_dwordx4 v[60:63], v3, s[28:29]
    s_mul_i32 s31, s3, 384
    v_lshlrev_b32 v4, 1, v0
    v_add_u32 v4, s31, v4
    s_lshl_b32 s32, s3, 1
    v_mov_b32 v5, s32
    s_waitcnt lgkmcnt(0)
    s_mov_b32 s6, 245760
    s_mov_b32 s7, 0x20000
    s_mov_b32 s10, 245760
    s_mov_b32 s11, 0x20000
    s_mov_b32 s14, 245760
    s_mov_b32 s15, 0x20000
    s_mov_b32 s18, 245760
    s_mov_b32 s19, 0x20000
    s_mov_b32 s22, 1280
    s_mov_b32 s23, 0x20000
    s_add_u32 s24, s24, 2883584
    s_addc_u32 s25, s25, 0
    s_mov_b32 s26, 2621440
    s_mov_b32 s27, 0x20000
    s_cmp_ge_u32 s30, 3
    s_cbranch_scc1 L_k1_kg_sync1
    buffer_load_ushort v6, v5, s[20:23], 0 offen
    buffer_load_ushort v7, v4, s[4:7], 0 offen
    buffer_load_ushort v8, v4, s[8:11], 0 offen
    buffer_load_ushort v9, v4, s[12:15], 0 offen
    buffer_load_ushort v10, v4, s[16:19], 0 offen
    s_mul_i32 s33, s30, 13568
    v_lshlrev_b32 v11, 2, v2
    v_xor_b32 v64, 0, v11
    v_xor_b32 v65, 16, v11
    v_xor_b32 v66, 32, v11
    v_xor_b32 v67, 48, v11
    v_xor_b32 v68, 64, v11
    v_xor_b32 v69, 80, v11
    v_xor_b32 v70, 96, v11
    v_xor_b32 v71, 112, v11
    v_xor_b32 v72, 128, v11
    v_xor_b32 v73, 144, v11
    v_xor_b32 v74, 160, v11
    v_xor_b32 v75, 176, v11
    v_xor_b32 v76, 192, v11
    v_xor_b32 v77, 208, v11
    v_xor_b32 v78, 224, v11
    v_xor_b32 v79, 240, v11
    v_add_u32 v64, s33, v64
    v_add_u32 v65, s33, v65
    v_add_u32 v66, s33, v66
    v_add_u32 v67, s33, v67
    v_add_u32 v68, s33, v68
    v_add_u32 v69, s33, v69
    v_add_u32 v70, s33, v70
    v_add_u32 v71, s33, v71
    v_add_u32 v72, s33, v72
    v_add_u32 v73, s33, v73
    v_add_u32 v74, s33, v74
    v_add_u32 v75, s33, v75
    v_add_u32 v76, s33, v76
    v_add_u32 v77, s33, v77
    v_add_u32 v78, s33, v78
    v_add_u32 v79, s33, v79
    v_and_b32 v12, 31, v2
    v_lshrrev_b32 v13, 5, v2
    v_and_b32 v14, 15, v12
    v_xor_b32 v14, v14, v13
    v_lshlrev_b32 v14, 4, v14
    v_lshl_add_u32 v14, v12, 8, v14
    v_add_u32 v14, s33, v14
    s_waitcnt vmcnt(0)
    v_lshlrev_b32 v6, 16, v6
    v_lshlrev_b32 v7, 16, v7
    v_lshlrev_b32 v8, 16, v8
    v_lshlrev_b32 v9, 16, v9
    v_lshlrev_b32 v10, 16, v10
    v_mul_f32 v6, 0x3fb8aa3b, v6
    v_mul_f32 v7, 0x3fb8aa3b, v7
    v_exp_f32 v6, v6
    v_exp_f32 v7, v7
    s_nop 0
    v_cvt_pk_bf16_f32 v6, v6, v7
    v_and_b32 v7, 0xffff0000, v6
    v_lshlrev_b32 v6, 16, v6
    v_mul_f32 v7, v7, v6
    v_mul_f32 v7, 0xbfb8aa3b, v7
    v_mul_f32 v8, v8, v6
    v_mul_f32 v8, 0x3e22f983, v8
    v_add_f32 v6, v6, v6
    v_mul_f32 v16, v9, v6
    v_mul_f32 v17, v10, v6
    v_sub_f32 v17, 0, v17
    v_mul_f32 v96, 0x3f800000, v7
    v_mul_f32 v97, 0xbf800000, v8
    v_mul_f32 v98, 0x43800000, v7
    v_mul_f32 v99, 0xc3800000, v8
    v_mul_f32 v100, 0x41000000, v7
    v_mul_f32 v101, 0x41000000, v8
    v_mul_f32 v102, 0x42800000, v7
    v_mul_f32 v103, 0x42800000, v8
    v_mul_f32 v104, 0x43000000, v7
    v_mul_f32 v105, 0x43000000, v8
    v_mul_f32 v106, 0x43400000, v7
    v_mul_f32 v107, 0x43400000, v8
    v_exp_f32 v96, v96
    v_exp_f32 v98, v98
    v_exp_f32 v100, v100
    v_exp_f32 v102, v102
    v_exp_f32 v104, v104
    v_exp_f32 v106, v106
    v_fract_f32 v97, v97
    v_fract_f32 v99, v99
    v_fract_f32 v101, v101
    v_fract_f32 v103, v103
    v_fract_f32 v105, v105
    v_fract_f32 v107, v107
    v_cos_f32 v18, v97
    v_cos_f32 v20, v99
    v_cos_f32 v22, v101
    v_cos_f32 v26, v103
    v_cos_f32 v28, v105
    v_cos_f32 v30, v107
    v_sin_f32 v19, v97
    v_sin_f32 v21, v99
    v_sin_f32 v23, v101
    v_sin_f32 v27, v103
    v_sin_f32 v29, v105
    v_sin_f32 v31, v107
    v_mul_f32 v18, v18, v96
    v_mul_f32 v20, v20, v98
    v_mul_f32 v22, v22, v100
    v_mul_f32 v26, v26, v102
    v_mul_f32 v28, v28, v104
    v_mul_f32 v30, v30, v106
    v_mul_f32 v19, v19, v96
    v_mul_f32 v21, v21, v98
    v_mul_f32 v23, v23, v100
    v_mul_f32 v27, v27, v102
    v_mul_f32 v29, v29, v104
    v_mul_f32 v31, v31, v106
    v_mov_b32 v24, 1.0
    v_mov_b32 v25, 0
    v_cvt_pk_bf16_f32 v52, v24, v25
    v_cvt_pk_bf16_f32 v53, v26, v27
    v_cvt_pk_bf16_f32 v54, v28, v29
    v_cvt_pk_bf16_f32 v55, v30, v31
    v_cvt_pk_bf16_f32 v56, v16, v17
    v_pk_mul_f32 v[80:81], v[18:19], v[18:19] op_sel:[0,0] op_sel_hi:[0,1]
    v_pk_mul_f32 v[82:83], v[16:17], v[20:21] op_sel:[0,0] op_sel_hi:[0,1]
    v_pk_mul_f32 v[84:85], v[16:17], v[18:19] op_sel:[0,0] op_sel_hi:[0,1]
    v_pk_mul_f32 v[86:87], v[24:25], v[22:23] op_sel:[0,0] op_sel_hi:[0,1]
    v_pk_mul_f32 v[88:89], v[26:27], v[22:23] op_sel:[0,0] op_sel_hi:[0,1]
    v_pk_mul_f32 v[90:91], v[28:29], v[22:23] op_sel:[0,0] op_sel_hi:[0,1]
    v_pk_mul_f32 v[92:93], v[30:31], v[22:23] op_sel:[0,0] op_sel_hi:[0,1]
    ds_write_b32 v64, v52 offset:5376
    ds_write_b32 v72, v53 offset:7424
    ds_write_b32 v64, v54 offset:9472
    ds_write_b32 v72, v55 offset:11520
    ds_write_b32 v64, v56 offset:0
    v_pk_fma_f32 v[34:35], v[18:19], v[18:19], v[80:81] op_sel:[1,1,0] op_sel_hi:[1,0,1] neg_lo:[1,0,0]
    v_pk_fma_f32 v[38:39], v[16:17], v[20:21], v[82:83] op_sel:[1,1,0] op_sel_hi:[1,0,1] neg_lo:[1,0,0]
    v_pk_fma_f32 v[32:33], v[16:17], v[18:19], v[84:85] op_sel:[1,1,0] op_sel_hi:[1,0,1] neg_lo:[1,0,0]
    v_pk_fma_f32 v[24:25], v[24:25], v[22:23], v[86:87] op_sel:[1,1,0] op_sel_hi:[1,0,1] neg_lo:[1,0,0]
    v_pk_fma_f32 v[26:27], v[26:27], v[22:23], v[88:89] op_sel:[1,1,0] op_sel_hi:[1,0,1] neg_lo:[1,0,0]
    v_pk_fma_f32 v[28:29], v[28:29], v[22:23], v[90:91] op_sel:[1,1,0] op_sel_hi:[1,0,1] neg_lo:[1,0,0]
    v_pk_fma_f32 v[30:31], v[30:31], v[22:23], v[92:93] op_sel:[1,1,0] op_sel_hi:[1,0,1] neg_lo:[1,0,0]
    v_cvt_pk_bf16_f32 v52, v24, v25
    v_cvt_pk_bf16_f32 v53, v26, v27
    v_cvt_pk_bf16_f32 v54, v28, v29
    v_cvt_pk_bf16_f32 v55, v30, v31
    v_cvt_pk_bf16_f32 v56, v32, v33
    v_cvt_pk_bf16_f32 v57, v38, v39
    v_pk_mul_f32 v[80:81], v[34:35], v[34:35] op_sel:[0,0] op_sel_hi:[0,1]
    v_pk_mul_f32 v[82:83], v[38:39], v[20:21] op_sel:[0,0] op_sel_hi:[0,1]
    v_pk_mul_f32 v[84:85], v[38:39], v[34:35] op_sel:[0,0] op_sel_hi:[0,1]
    v_pk_mul_f32 v[86:87], v[32:33], v[18:19] op_sel:[0,0] op_sel_hi:[0,1]
    v_pk_mul_f32 v[88:89], v[24:25], v[22:23] op_sel:[0,0] op_sel_hi:[0,1]
    v_pk_mul_f32 v[90:91], v[26:27], v[22:23] op_sel:[0,0] op_sel_hi:[0,1]
    v_pk_mul_f32 v[92:93], v[28:29], v[22:23] op_sel:[0,0] op_sel_hi:[0,1]
    v_pk_mul_f32 v[94:95], v[30:31], v[22:23] op_sel:[0,0] op_sel_hi:[0,1]
    ds_write_b32 v65, v52 offset:5632
    ds_write_b32 v73, v53 offset:7680
    ds_write_b32 v65, v54 offset:9728
    ds_write_b32 v73, v55 offset:11776
    ds_write_b32 v65, v56 offset:256
    ds_write_b32 v72, v57 offset:2048
    v_pk_fma_f32 v[36:37], v[34:35], v[34:35], v[80:81] op_sel:[1,1,0] op_sel_hi:[1,0,1] neg_lo:[1,0,0]
    v_pk_fma_f32 v[40:41], v[38:39], v[20:21], v[82:83] op_sel:[1,1,0] op_sel_hi:[1,0,1] neg_lo:[1,0,0]
    v_pk_fma_f32 v[46:47], v[38:39], v[34:35], v[84:85] op_sel:[1,1,0] op_sel_hi:[1,0,1] neg_lo:[1,0,0]
    v_pk_fma_f32 v[32:33], v[32:33], v[18:19], v[86:87] op_sel:[1,1,0] op_sel_hi:[1,0,1] neg_lo:[1,0,0]
    v_pk_fma_f32 v[24:25], v[24:25], v[22:23], v[88:89] op_sel:[1,1,0] op_sel_hi:[1,0,1] neg_lo:[1,0,0]
    v_pk_fma_f32 v[26:27], v[26:27], v[22:23], v[90:91] op_sel:[1,1,0] op_sel_hi:[1,0,1] neg_lo:[1,0,0]
    v_pk_fma_f32 v[28:29], v[28:29], v[22:23], v[92:93] op_sel:[1,1,0] op_sel_hi:[1,0,1] neg_lo:[1,0,0]
    v_pk_fma_f32 v[30:31], v[30:31], v[22:23], v[94:95] op_sel:[1,1,0] op_sel_hi:[1,0,1] neg_lo:[1,0,0]
    v_cvt_pk_bf16_f32 v52, v24, v25
    v_cvt_pk_bf16_f32 v53, v26, v27
    v_cvt_pk_bf16_f32 v54, v28, v29
    v_cvt_pk_bf16_f32 v55, v30, v31
    v_cvt_pk_bf16_f32 v56, v32, v33
    v_cvt_pk_bf16_f32 v57, v40, v41
    v_cvt_pk_bf16_f32 v58, v46, v47
    v_pk_mul_f32 v[80:81], v[40:41], v[20:21] op_sel:[0,0] op_sel_hi:[0,1]
    v_pk_mul_f32 v[82:83], v[40:41], v[36:37] op_sel:[0,0] op_sel_hi:[0,1]
    v_pk_mul_f32 v[84:85], v[46:47], v[34:35] op_sel:[0,0] op_sel_hi:[0,1]
    v_pk_mul_f32 v[86:87], v[32:33], v[18:19] op_sel:[0,0] op_sel_hi:[0,1]
    v_pk_mul_f32 v[88:89], v[24:25], v[22:23] op_sel:[0,0] op_sel_hi:[0,1]
    v_pk_mul_f32 v[90:91], v[26:27], v[22:23] op_sel:[0,0] op_sel_hi:[0,1]
    v_pk_mul_f32 v[92:93], v[28:29], v[22:23] op_sel:[0,0] op_sel_hi:[0,1]
    v_pk_mul_f32 v[94:95], v[30:31], v[22:23] op_sel:[0,0] op_sel_hi:[0,1]
    ds_write_b32 v66, v52 offset:5888
    ds_write_b32 v74, v53 offset:7936
    ds_write_b32 v66, v54 offset:9984
    ds_write_b32 v74, v55 offset:12032
    ds_write_b32 v66, v56 offset:512
    ds_write_b32 v76, v57 offset:3072
    ds_write_b32 v73, v58 offset:2304
    v_pk_fma_f32 v[42:43], v[40:41], v[20:21], v[80:81] op_sel:[1,1,0] op_sel_hi:[1,0,1] neg_lo:[1,0,0]
    v_pk_fma_f32 v[48:49], v[40:41], v[36:37], v[82:83] op_sel:[1,1,0] op_sel_hi:[1,0,1] neg_lo:[1,0,0]
    v_pk_fma_f32 v[46:47], v[46:47], v[34:35], v[84:85] op_sel:[1,1,0] op_sel_hi:[1,0,1] neg_lo:[1,0,0]
    v_pk_fma_f32 v[32:33], v[32:33], v[18:19], v[86:87] op_sel:[1,1,0] op_sel_hi:[1,0,1] neg_lo:[1,0,0]
    v_pk_fma_f32 v[24:25], v[24:25], v[22:23], v[88:89] op_sel:[1,1,0] op_sel_hi:[1,0,1] neg_lo:[1,0,0]
    v_pk_fma_f32 v[26:27], v[26:27], v[22:23], v[90:91] op_sel:[1,1,0] op_sel_hi:[1,0,1] neg_lo:[1,0,0]
    v_pk_fma_f32 v[28:29], v[28:29], v[22:23], v[92:93] op_sel:[1,1,0] op_sel_hi:[1,0,1] neg_lo:[1,0,0]
    v_pk_fma_f32 v[30:31], v[30:31], v[22:23], v[94:95] op_sel:[1,1,0] op_sel_hi:[1,0,1] neg_lo:[1,0,0]
    v_cvt_pk_bf16_f32 v52, v24, v25
    v_cvt_pk_bf16_f32 v53, v26, v27
    v_cvt_pk_bf16_f32 v54, v28, v29
    v_cvt_pk_bf16_f32 v55, v30, v31
    v_cvt_pk_bf16_f32 v56, v32, v33
    v_cvt_pk_bf16_f32 v57, v42, v43
    v_cvt_pk_bf16_f32 v58, v46, v47
    v_cvt_pk_bf16_f32 v59, v48, v49
    v_pk_mul_f32 v[80:81], v[42:43], v[20:21] op_sel:[0,0] op_sel_hi:[0,1]
    v_pk_mul_f32 v[82:83], v[42:43], v[36:37] op_sel:[0,0] op_sel_hi:[0,1]
    v_pk_mul_f32 v[84:85], v[46:47], v[34:35] op_sel:[0,0] op_sel_hi:[0,1]
    v_pk_mul_f32 v[86:87], v[32:33], v[18:19] op_sel:[0,0] op_sel_hi:[0,1]
    v_pk_mul_f32 v[88:89], v[24:25], v[22:23] op_sel:[0,0] op_sel_hi:[0,1]
    v_pk_mul_f32 v[90:91], v[26:27], v[22:23] op_sel:[0,0] op_sel_hi:[0,1]
    v_pk_mul_f32 v[92:93], v[28:29], v[22:23] op_sel:[0,0] op_sel_hi:[0,1]
    v_pk_mul_f32 v[94:95], v[30:31], v[22:23] op_sel:[0,0] op_sel_hi:[0,1]
    ds_write_b32 v67, v52 offset:6144
    ds_write_b32 v75, v53 offset:8192
    ds_write_b32 v67, v54 offset:10240
    ds_write_b32 v75, v55 offset:12288
    ds_write_b32 v67, v56 offset:768
    ds_write_b32 v78, v57 offset:3584
    ds_write_b32 v74, v58 offset:2560
    ds_write_b32 v77, v59 offset:3328
    v_pk_fma_f32 v[44:45], v[42:43], v[20:21], v[80:81] op_sel:[1,1,0] op_sel_hi:[1,0,1] neg_lo:[1,0,0]
    v_pk_fma_f32 v[50:51], v[42:43], v[36:37], v[82:83] op_sel:[1,1,0] op_sel_hi:[1,0,1] neg_lo:[1,0,0]
    v_pk_fma_f32 v[46:47], v[46:47], v[34:35], v[84:85] op_sel:[1,1,0] op_sel_hi:[1,0,1] neg_lo:[1,0,0]
    v_pk_fma_f32 v[32:33], v[32:33], v[18:19], v[86:87] op_sel:[1,1,0] op_sel_hi:[1,0,1] neg_lo:[1,0,0]
    v_pk_fma_f32 v[24:25], v[24:25], v[22:23], v[88:89] op_sel:[1,1,0] op_sel_hi:[1,0,1] neg_lo:[1,0,0]
    v_pk_fma_f32 v[26:27], v[26:27], v[22:23], v[90:91] op_sel:[1,1,0] op_sel_hi:[1,0,1] neg_lo:[1,0,0]
    v_pk_fma_f32 v[28:29], v[28:29], v[22:23], v[92:93] op_sel:[1,1,0] op_sel_hi:[1,0,1] neg_lo:[1,0,0]
    v_pk_fma_f32 v[30:31], v[30:31], v[22:23], v[94:95] op_sel:[1,1,0] op_sel_hi:[1,0,1] neg_lo:[1,0,0]
    v_cvt_pk_bf16_f32 v52, v24, v25
    v_cvt_pk_bf16_f32 v53, v26, v27
    v_cvt_pk_bf16_f32 v54, v28, v29
    v_cvt_pk_bf16_f32 v55, v30, v31
    v_cvt_pk_bf16_f32 v56, v32, v33
    v_cvt_pk_bf16_f32 v57, v44, v45
    v_cvt_pk_bf16_f32 v58, v46, v47
    v_cvt_pk_bf16_f32 v59, v50, v51
    v_pk_mul_f32 v[80:81], v[44:45], v[20:21] op_sel:[0,0] op_sel_hi:[0,1]
    v_pk_mul_f32 v[82:83], v[32:33], v[18:19] op_sel:[0,0] op_sel_hi:[0,1]
    v_pk_mul_f32 v[84:85], v[24:25], v[22:23] op_sel:[0,0] op_sel_hi:[0,1]
    v_pk_mul_f32 v[86:87], v[26:27], v[22:23] op_sel:[0,0] op_sel_hi:[0,1]
    v_pk_mul_f32 v[88:89], v[28:29], v[22:23] op_sel:[0,0] op_sel_hi:[0,1]
    v_pk_mul_f32 v[90:91], v[30:31], v[22:23] op_sel:[0,0] op_sel_hi:[0,1]
    ds_write_b32 v68, v52 offset:6400
    ds_write_b32 v76, v53 offset:8448
    ds_write_b32 v68, v54 offset:10496
    ds_write_b32 v76, v55 offset:12544
    ds_write_b32 v68, v56 offset:1024
    ds_write_b32 v64, v57 offset:4096
    ds_write_b32 v75, v58 offset:2816
    ds_write_b32 v79, v59 offset:3840
    v_pk_fma_f32 v[44:45], v[44:45], v[20:21], v[80:81] op_sel:[1,1,0] op_sel_hi:[1,0,1] neg_lo:[1,0,0]
    v_pk_fma_f32 v[32:33], v[32:33], v[18:19], v[82:83] op_sel:[1,1,0] op_sel_hi:[1,0,1] neg_lo:[1,0,0]
    v_pk_fma_f32 v[24:25], v[24:25], v[22:23], v[84:85] op_sel:[1,1,0] op_sel_hi:[1,0,1] neg_lo:[1,0,0]
    v_pk_fma_f32 v[26:27], v[26:27], v[22:23], v[86:87] op_sel:[1,1,0] op_sel_hi:[1,0,1] neg_lo:[1,0,0]
    v_pk_fma_f32 v[28:29], v[28:29], v[22:23], v[88:89] op_sel:[1,1,0] op_sel_hi:[1,0,1] neg_lo:[1,0,0]
    v_pk_fma_f32 v[30:31], v[30:31], v[22:23], v[90:91] op_sel:[1,1,0] op_sel_hi:[1,0,1] neg_lo:[1,0,0]
    v_cvt_pk_bf16_f32 v52, v24, v25
    v_cvt_pk_bf16_f32 v53, v26, v27
    v_cvt_pk_bf16_f32 v54, v28, v29
    v_cvt_pk_bf16_f32 v55, v30, v31
    v_cvt_pk_bf16_f32 v56, v32, v33
    v_cvt_pk_bf16_f32 v57, v44, v45
    v_pk_mul_f32 v[80:81], v[44:45], v[20:21] op_sel:[0,0] op_sel_hi:[0,1]
    v_pk_mul_f32 v[82:83], v[32:33], v[18:19] op_sel:[0,0] op_sel_hi:[0,1]
    v_pk_mul_f32 v[84:85], v[24:25], v[22:23] op_sel:[0,0] op_sel_hi:[0,1]
    v_pk_mul_f32 v[86:87], v[26:27], v[22:23] op_sel:[0,0] op_sel_hi:[0,1]
    v_pk_mul_f32 v[88:89], v[28:29], v[22:23] op_sel:[0,0] op_sel_hi:[0,1]
    v_pk_mul_f32 v[90:91], v[30:31], v[22:23] op_sel:[0,0] op_sel_hi:[0,1]
    ds_write_b32 v69, v52 offset:6656
    ds_write_b32 v77, v53 offset:8704
    ds_write_b32 v69, v54 offset:10752
    ds_write_b32 v77, v55 offset:12800
    ds_write_b32 v69, v56 offset:1280
    ds_write_b32 v65, v57 offset:4352
    v_pk_fma_f32 v[44:45], v[44:45], v[20:21], v[80:81] op_sel:[1,1,0] op_sel_hi:[1,0,1] neg_lo:[1,0,0]
    v_pk_fma_f32 v[32:33], v[32:33], v[18:19], v[82:83] op_sel:[1,1,0] op_sel_hi:[1,0,1] neg_lo:[1,0,0]
    v_pk_fma_f32 v[24:25], v[24:25], v[22:23], v[84:85] op_sel:[1,1,0] op_sel_hi:[1,0,1] neg_lo:[1,0,0]
    v_pk_fma_f32 v[26:27], v[26:27], v[22:23], v[86:87] op_sel:[1,1,0] op_sel_hi:[1,0,1] neg_lo:[1,0,0]
    v_pk_fma_f32 v[28:29], v[28:29], v[22:23], v[88:89] op_sel:[1,1,0] op_sel_hi:[1,0,1] neg_lo:[1,0,0]
    v_pk_fma_f32 v[30:31], v[30:31], v[22:23], v[90:91] op_sel:[1,1,0] op_sel_hi:[1,0,1] neg_lo:[1,0,0]
    v_cvt_pk_bf16_f32 v52, v24, v25
    v_cvt_pk_bf16_f32 v53, v26, v27
    v_cvt_pk_bf16_f32 v54, v28, v29
    v_cvt_pk_bf16_f32 v55, v30, v31
    v_cvt_pk_bf16_f32 v56, v32, v33
    v_cvt_pk_bf16_f32 v57, v44, v45
    v_pk_mul_f32 v[80:81], v[44:45], v[20:21] op_sel:[0,0] op_sel_hi:[0,1]
    v_pk_mul_f32 v[82:83], v[32:33], v[18:19] op_sel:[0,0] op_sel_hi:[0,1]
    v_pk_mul_f32 v[84:85], v[24:25], v[22:23] op_sel:[0,0] op_sel_hi:[0,1]
    v_pk_mul_f32 v[86:87], v[26:27], v[22:23] op_sel:[0,0] op_sel_hi:[0,1]
    v_pk_mul_f32 v[88:89], v[28:29], v[22:23] op_sel:[0,0] op_sel_hi:[0,1]
    v_pk_mul_f32 v[90:91], v[30:31], v[22:23] op_sel:[0,0] op_sel_hi:[0,1]
    ds_write_b32 v70, v52 offset:6912
    ds_write_b32 v78, v53 offset:8960
    ds_write_b32 v70, v54 offset:11008
    ds_write_b32 v78, v55 offset:13056
    ds_write_b32 v70, v56 offset:1536
    ds_write_b32 v66, v57 offset:4608
    v_pk_fma_f32 v[44:45], v[44:45], v[20:21], v[80:81] op_sel:[1,1,0] op_sel_hi:[1,0,1] neg_lo:[1,0,0]
    v_pk_fma_f32 v[32:33], v[32:33], v[18:19], v[82:83] op_sel:[1,1,0] op_sel_hi:[1,0,1] neg_lo:[1,0,0]
    v_pk_fma_f32 v[24:25], v[24:25], v[22:23], v[84:85] op_sel:[1,1,0] op_sel_hi:[1,0,1] neg_lo:[1,0,0]
    v_pk_fma_f32 v[26:27], v[26:27], v[22:23], v[86:87] op_sel:[1,1,0] op_sel_hi:[1,0,1] neg_lo:[1,0,0]
    v_pk_fma_f32 v[28:29], v[28:29], v[22:23], v[88:89] op_sel:[1,1,0] op_sel_hi:[1,0,1] neg_lo:[1,0,0]
    v_pk_fma_f32 v[30:31], v[30:31], v[22:23], v[90:91] op_sel:[1,1,0] op_sel_hi:[1,0,1] neg_lo:[1,0,0]
    v_cvt_pk_bf16_f32 v52, v24, v25
    v_cvt_pk_bf16_f32 v53, v26, v27
    v_cvt_pk_bf16_f32 v54, v28, v29
    v_cvt_pk_bf16_f32 v55, v30, v31
    v_cvt_pk_bf16_f32 v56, v32, v33
    v_cvt_pk_bf16_f32 v57, v44, v45
    v_pk_mul_f32 v[80:81], v[44:45], v[20:21] op_sel:[0,0] op_sel_hi:[0,1]
    ds_write_b32 v71, v52 offset:7168
    ds_write_b32 v79, v53 offset:9216
    ds_write_b32 v71, v54 offset:11264
    ds_write_b32 v79, v55 offset:13312
    ds_write_b32 v71, v56 offset:1792
    ds_write_b32 v67, v57 offset:4864
    v_pk_fma_f32 v[44:45], v[44:45], v[20:21], v[80:81] op_sel:[1,1,0] op_sel_hi:[1,0,1] neg_lo:[1,0,0]
    v_cvt_pk_bf16_f32 v52, v44, v45
    ds_write_b32 v68, v52 offset:5120
    s_waitcnt lgkmcnt(0)
    v_xor_b32 v15, 0, v14
    ds_read_b128 v[24:27], v15
    ds_read_b128 v[28:31], v15 offset:5376
    v_xor_b32 v15, 32, v14
    ds_read_b128 v[32:35], v15
    ds_read_b128 v[36:39], v15 offset:5376
    s_waitcnt lgkmcnt(2)
    v_mfma_f32_32x32x16_bf16 v[96:111], v[24:27], v[28:31], 0
    v_xor_b32 v15, 64, v14
    ds_read_b128 v[40:43], v15
    ds_read_b128 v[44:47], v15 offset:5376
    s_waitcnt lgkmcnt(2)
    v_mfma_f32_32x32x16_bf16 v[96:111], v[32:35], v[36:39], v[96:111]
    v_xor_b32 v15, 96, v14
    ds_read_b128 v[48:51], v15
    ds_read_b128 v[52:55], v15 offset:5376
    s_waitcnt lgkmcnt(2)
    v_mfma_f32_32x32x16_bf16 v[96:111], v[40:43], v[44:47], v[96:111]
    v_xor_b32 v15, 128, v14
    ds_read_b128 v[24:27], v15
    ds_read_b128 v[28:31], v15 offset:5376
    s_waitcnt lgkmcnt(2)
    v_mfma_f32_32x32x16_bf16 v[96:111], v[48:51], v[52:55], v[96:111]
    v_xor_b32 v15, 160, v14
    ds_read_b128 v[32:35], v15
    ds_read_b128 v[36:39], v15 offset:5376
    s_waitcnt lgkmcnt(2)
    v_mfma_f32_32x32x16_bf16 v[96:111], v[24:27], v[28:31], v[96:111]
    v_xor_b32 v15, 192, v14
    ds_read_b128 v[40:43], v15
    ds_read_b128 v[44:47], v15 offset:5376
    s_waitcnt lgkmcnt(2)
    v_mfma_f32_32x32x16_bf16 v[96:111], v[32:35], v[36:39], v[96:111]
    v_xor_b32 v15, 224, v14
    ds_read_b128 v[48:51], v15
    ds_read_b128 v[52:55], v15 offset:5376
    s_waitcnt lgkmcnt(2)
    v_mfma_f32_32x32x16_bf16 v[96:111], v[40:43], v[44:47], v[96:111]
    s_waitcnt lgkmcnt(0)
    v_mfma_f32_32x32x16_bf16 v[96:111], v[48:51], v[52:55], v[96:111]
    v_and_b32 v12, 31, v2
    v_lshrrev_b32 v13, 5, v2
    v_lshlrev_b32 v12, 2, v12
    v_lshl_add_u32 v12, v13, 9, v12
    v_add_u32 v12, s33, v12
    s_nop 6
    ds_write_b32 v12, v96 offset:0
    ds_write_b32 v12, v97 offset:128
    ds_write_b32 v12, v98 offset:256
    ds_write_b32 v12, v99 offset:384
    ds_write_b32 v12, v100 offset:1024
    ds_write_b32 v12, v101 offset:1152
    ds_write_b32 v12, v102 offset:1280
    ds_write_b32 v12, v103 offset:1408
    ds_write_b32 v12, v104 offset:2048
    ds_write_b32 v12, v105 offset:2176
    ds_write_b32 v12, v106 offset:2304
    ds_write_b32 v12, v107 offset:2432
L_k1_kg_sync1:
    s_setprio 1
    s_waitcnt lgkmcnt(0)
    s_barrier
    v_cmp_gt_u32 vcc, 168, v0
    s_nop 3
    s_and_saveexec_b64 s[34:35], vcc
    s_cbranch_execz L_k1_kg_skip
    ds_read_b128 v[24:27], v3
    ds_read_b128 v[28:31], v3 offset:13568
    ds_read_b128 v[32:35], v3 offset:27136
    s_waitcnt lgkmcnt(0)
    v_pk_add_f32 v[24:25], v[24:25], v[28:29]
    v_pk_add_f32 v[26:27], v[26:27], v[30:31]
    v_pk_add_f32 v[24:25], v[24:25], v[32:33]
    v_pk_add_f32 v[26:27], v[26:27], v[34:35]
    v_cvt_pk_bf16_f32 v24, v24, v25
    v_cvt_pk_bf16_f32 v25, v26, v27
    v_lshlrev_b32 v12, 3, v0
    ds_write_b64 v12, v[24:25] offset:4096
L_k1_kg_skip:
    s_mov_b64 exec, s[34:35]
    s_waitcnt vmcnt(0) lgkmcnt(0)
    s_barrier
    v_and_b32 v24, 0xffff, v60
    v_lshrrev_b32 v25, 16, v60
    v_and_b32 v26, 0xffff, v61
    v_lshrrev_b32 v27, 16, v61
    v_and_b32 v28, 0xffff, v62
    v_lshrrev_b32 v29, 16, v62
    v_and_b32 v30, 0xffff, v63
    v_lshrrev_b32 v31, 16, v63
    ds_read_u16 v36, v24 offset:4096
    ds_read_u16 v40, v25 offset:4096
    ds_read_u16 v37, v26 offset:4096
    ds_read_u16 v41, v27 offset:4096
    ds_read_u16 v38, v28 offset:4096
    ds_read_u16 v42, v29 offset:4096
    ds_read_u16 v39, v30 offset:4096
    ds_read_u16 v43, v31 offset:4096
    s_lshl_b32 s33, s3, 12
    s_waitcnt lgkmcnt(0)
    v_lshl_or_b32 v36, v40, 16, v36
    v_lshl_or_b32 v37, v41, 16, v37
    v_lshl_or_b32 v38, v42, 16, v38
    v_lshl_or_b32 v39, v43, 16, v39
    buffer_store_dwordx4 v[36:39], v3, s[24:27], s33 offen sc0 sc1
    s_endpgm
L_k1_ln:
    s_load_dwordx2 s[4:5], s[0:1], 0
    s_load_dwordx2 s[8:9], s[0:1], 120
    s_load_dwordx2 s[12:13], s[0:1], 120
    v_lshrrev_b32 v1, 4, v0
    v_and_b32 v2, 15, v0
    s_sub_u32 s3, s2, 640
    s_lshl_b32 s3, s3, 5
    v_add_u32 v3, s3, v1
    v_mul_u32_u24 v4, 1280, v3
    v_lshl_add_u32 v4, v2, 4, v4
    s_mov_b32 s16, 20480
    s_mov_b32 s17, 0x3f803f80
    s_waitcnt lgkmcnt(0)
    s_mov_b32 s6, 2621440
    s_mov_b32 s7, 0x20000
    s_add_u32 s8, s8, 65536
    s_addc_u32 s9, s9, 0
    s_mov_b32 s10, 8192
    s_mov_b32 s11, 0x20000
    s_add_u32 s12, s12, 262144
    s_addc_u32 s13, s13, 0
    s_mov_b32 s14, 2621440
    s_mov_b32 s15, 0x20000
    buffer_load_dwordx4 v[16:19], v4, s[4:7], 0 offen offset:0 nt
    buffer_load_dwordx4 v[20:23], v4, s[4:7], 0 offen offset:256 nt
    buffer_load_dwordx4 v[24:27], v4, s[4:7], 0 offen offset:512 nt
    buffer_load_dwordx4 v[28:31], v4, s[4:7], 0 offen offset:768 nt
    buffer_load_dwordx4 v[32:35], v4, s[4:7], 0 offen offset:1024 nt
    buffer_load_dwordx4 v[36:39], v4, s[4:7], s16 offen offset:0 nt
    buffer_load_dwordx4 v[40:43], v4, s[4:7], s16 offen offset:256 nt
    buffer_load_dwordx4 v[44:47], v4, s[4:7], s16 offen offset:512 nt
    buffer_load_dwordx4 v[48:51], v4, s[4:7], s16 offen offset:768 nt
    buffer_load_dwordx4 v[52:55], v4, s[4:7], s16 offen offset:1024 nt
    v_and_b32 v5, 3, v1
    v_lshrrev_b32 v6, 3, v1
    v_lshl_or_b32 v5, v6, 2, v5
    v_xor_b32 v5, v5, v2
    v_mul_u32_u24 v6, 1280, v1
    v_xor_b32 v7, 8, v5
    v_lshl_add_u32 v5, v5, 4, v6
    v_lshl_add_u32 v6, v7, 4, v6
    s_waitcnt vmcnt(5)
    ds_write_b128 v5, v[16:19] offset:0
    ds_write_b128 v5, v[20:23] offset:256
    ds_write_b128 v5, v[24:27] offset:512
    ds_write_b128 v5, v[28:31] offset:768
    ds_write_b128 v5, v[32:35] offset:1024
    v_dot2_f32_bf16 v8, v16, s17, 0
    v_dot2_f32_bf16 v9, v16, v16, 0
    v_dot2_f32_bf16 v8, v17, s17, v8
    v_dot2_f32_bf16 v9, v17, v17, v9
    v_dot2_f32_bf16 v8, v18, s17, v8
    v_dot2_f32_bf16 v9, v18, v18, v9
    v_dot2_f32_bf16 v8, v19, s17, v8
    v_dot2_f32_bf16 v9, v19, v19, v9
    v_dot2_f32_bf16 v8, v20, s17, v8
    v_dot2_f32_bf16 v9, v20, v20, v9
    v_dot2_f32_bf16 v8, v21, s17, v8
    v_dot2_f32_bf16 v9, v21, v21, v9
    v_dot2_f32_bf16 v8, v22, s17, v8
    v_dot2_f32_bf16 v9, v22, v22, v9
    v_dot2_f32_bf16 v8, v23, s17, v8
    v_dot2_f32_bf16 v9, v23, v23, v9
    v_dot2_f32_bf16 v8, v24, s17, v8
    v_dot2_f32_bf16 v9, v24, v24, v9
    v_dot2_f32_bf16 v8, v25, s17, v8
    v_dot2_f32_bf16 v9, v25, v25, v9
    v_dot2_f32_bf16 v8, v26, s17, v8
    v_dot2_f32_bf16 v9, v26, v26, v9
    v_dot2_f32_bf16 v8, v27, s17, v8
    v_dot2_f32_bf16 v9, v27, v27, v9
    v_dot2_f32_bf16 v8, v28, s17, v8
    v_dot2_f32_bf16 v9, v28, v28, v9
    v_dot2_f32_bf16 v8, v29, s17, v8
    v_dot2_f32_bf16 v9, v29, v29, v9
    v_dot2_f32_bf16 v8, v30, s17, v8
    v_dot2_f32_bf16 v9, v30, v30, v9
    v_dot2_f32_bf16 v8, v31, s17, v8
    v_dot2_f32_bf16 v9, v31, v31, v9
    v_dot2_f32_bf16 v8, v32, s17, v8
    v_dot2_f32_bf16 v9, v32, v32, v9
    v_dot2_f32_bf16 v8, v33, s17, v8
    v_dot2_f32_bf16 v9, v33, v33, v9
    v_dot2_f32_bf16 v8, v34, s17, v8
    v_dot2_f32_bf16 v9, v34, v34, v9
    v_dot2_f32_bf16 v8, v35, s17, v8
    v_dot2_f32_bf16 v9, v35, v35, v9
    s_waitcnt vmcnt(0)
    ds_write_b128 v6, v[36:39] offset:20480
    ds_write_b128 v6, v[40:43] offset:20736
    ds_write_b128 v6, v[44:47] offset:20992
    ds_write_b128 v6, v[48:51] offset:21248
    ds_write_b128 v6, v[52:55] offset:21504
    v_dot2_f32_bf16 v10, v36, s17, 0
    v_dot2_f32_bf16 v11, v36, v36, 0
    v_dot2_f32_bf16 v10, v37, s17, v10
    v_dot2_f32_bf16 v11, v37, v37, v11
    v_dot2_f32_bf16 v10, v38, s17, v10
    v_dot2_f32_bf16 v11, v38, v38, v11
    v_dot2_f32_bf16 v10, v39, s17, v10
    v_dot2_f32_bf16 v11, v39, v39, v11
    v_dot2_f32_bf16 v10, v40, s17, v10
    v_dot2_f32_bf16 v11, v40, v40, v11
    v_dot2_f32_bf16 v10, v41, s17, v10
    v_dot2_f32_bf16 v11, v41, v41, v11
    v_dot2_f32_bf16 v10, v42, s17, v10
    v_dot2_f32_bf16 v11, v42, v42, v11
    v_dot2_f32_bf16 v10, v43, s17, v10
    v_dot2_f32_bf16 v11, v43, v43, v11
    v_dot2_f32_bf16 v10, v44, s17, v10
    v_dot2_f32_bf16 v11, v44, v44, v11
    v_dot2_f32_bf16 v10, v45, s17, v10
    v_dot2_f32_bf16 v11, v45, v45, v11
    v_dot2_f32_bf16 v10, v46, s17, v10
    v_dot2_f32_bf16 v11, v46, v46, v11
    v_dot2_f32_bf16 v10, v47, s17, v10
    v_dot2_f32_bf16 v11, v47, v47, v11
    v_dot2_f32_bf16 v10, v48, s17, v10
    v_dot2_f32_bf16 v11, v48, v48, v11
    v_dot2_f32_bf16 v10, v49, s17, v10
    v_dot2_f32_bf16 v11, v49, v49, v11
    v_dot2_f32_bf16 v10, v50, s17, v10
    v_dot2_f32_bf16 v11, v50, v50, v11
    v_dot2_f32_bf16 v10, v51, s17, v10
    v_dot2_f32_bf16 v11, v51, v51, v11
    v_dot2_f32_bf16 v10, v52, s17, v10
    v_dot2_f32_bf16 v11, v52, v52, v11
    v_dot2_f32_bf16 v10, v53, s17, v10
    v_dot2_f32_bf16 v11, v53, v53, v11
    v_dot2_f32_bf16 v10, v54, s17, v10
    v_dot2_f32_bf16 v11, v54, v54, v11
    v_dot2_f32_bf16 v10, v55, s17, v10
    v_dot2_f32_bf16 v11, v55, v55, v11
    v_add_f32_dpp v8, v8, v8 row_ror:8 row_mask:0xf bank_mask:0xf
    v_add_f32_dpp v9, v9, v9 row_ror:8 row_mask:0xf bank_mask:0xf
    v_add_f32_dpp v10, v10, v10 row_ror:8 row_mask:0xf bank_mask:0xf
    v_add_f32_dpp v11, v11, v11 row_ror:8 row_mask:0xf bank_mask:0xf
    v_add_f32_dpp v8, v8, v8 row_ror:4 row_mask:0xf bank_mask:0xf
    v_add_f32_dpp v9, v9, v9 row_ror:4 row_mask:0xf bank_mask:0xf
    v_add_f32_dpp v10, v10, v10 row_ror:4 row_mask:0xf bank_mask:0xf
    v_add_f32_dpp v11, v11, v11 row_ror:4 row_mask:0xf bank_mask:0xf
    v_add_f32_dpp v8, v8, v8 row_ror:2 row_mask:0xf bank_mask:0xf
    v_add_f32_dpp v9, v9, v9 row_ror:2 row_mask:0xf bank_mask:0xf
    v_add_f32_dpp v10, v10, v10 row_ror:2 row_mask:0xf bank_mask:0xf
    v_add_f32_dpp v11, v11, v11 row_ror:2 row_mask:0xf bank_mask:0xf
    v_add_f32_dpp v8, v8, v8 row_ror:1 row_mask:0xf bank_mask:0xf
    v_add_f32_dpp v9, v9, v9 row_ror:1 row_mask:0xf bank_mask:0xf
    v_add_f32_dpp v10, v10, v10 row_ror:1 row_mask:0xf bank_mask:0xf
    v_add_f32_dpp v11, v11, v11 row_ror:1 row_mask:0xf bank_mask:0xf
    v_mul_f32 v8, 0x3acccccd, v8
    v_mul_f32 v9, 0x3acccccd, v9
    v_fma_f32 v9, -v8, v8, v9
    v_max_f32 v9, 0, v9
    v_cvt_pk_bf16_f32 v9, v9, v9
    v_lshlrev_b32 v9, 16, v9
    v_add_f32 v9, 0x3727c5ac, v9
    v_cvt_pk_bf16_f32 v9, v9, v9
    v_lshlrev_b32 v9, 16, v9
    v_sqrt_f32 v9, v9
    s_nop 0
    v_cvt_pk_bf16_f32 v8, v8, v9
    v_mul_f32 v10, 0x3acccccd, v10
    v_mul_f32 v11, 0x3acccccd, v11
    v_fma_f32 v11, -v10, v10, v11
    v_max_f32 v11, 0, v11
    v_cvt_pk_bf16_f32 v11, v11, v11
    v_lshlrev_b32 v11, 16, v11
    v_add_f32 v11, 0x3727c5ac, v11
    v_cvt_pk_bf16_f32 v11, v11, v11
    v_lshlrev_b32 v11, 16, v11
    v_sqrt_f32 v11, v11
    s_nop 0
    v_cvt_pk_bf16_f32 v10, v10, v11
    v_lshlrev_b32 v7, 2, v3
    v_cmp_eq_u32 vcc, 0, v2
    s_nop 3
    s_and_saveexec_b64 s[18:19], vcc
    s_cbranch_execz L_k1_ln_nost
    buffer_store_dword v8, v7, s[8:11], 0 offen sc0 sc1
    buffer_store_dword v10, v7, s[8:11], 0 offen offset:64 sc0 sc1
L_k1_ln_nost:
    s_mov_b64 exec, s[18:19]
    v_and_b32 v1, 63, v0
    v_lshrrev_b32 v2, 6, v0
    v_lshrrev_b32 v3, 4, v1
    v_and_b32 v4, 15, v1
    v_lshrrev_b32 v5, 2, v4
    v_and_b32 v6, 3, v4
    v_lshl_add_u32 v7, v6, 3, v5
    v_lshl_or_b32 v8, v6, 2, v5
    v_mul_u32_u24 v7, 1280, v7
    v_and_b32 v9, 1, v3
    v_lshl_add_u32 v7, v9, 3, v7
    v_lshrrev_b32 v9, 1, v3
    v_mul_u32_u24 v10, 20, v2
    v_add_u32 v9, v9, v10
    v_mul_u32_u24 v10, 40, v2
    v_add_u32 v10, v10, v3
    v_lshlrev_b32 v10, 14, v10
    v_lshl_add_u32 v10, v5, 6, v10
    v_lshl_add_u32 v10, v6, 4, v10
    s_lshl_b32 s16, s3, 3
    v_add_u32 v10, s16, v10
    s_waitcnt lgkmcnt(0)
    s_barrier
    v_add_u32 v11, 0, v9
    v_xor_b32 v11, v11, v8
    v_lshl_add_u32 v11, v11, 4, v7
    ds_read_b64_tr_b16 v[16:17], v11
    ds_read_b64_tr_b16 v[18:19], v11 offset:5120
    v_add_u32 v11, 2, v9
    v_xor_b32 v11, v11, v8
    v_lshl_add_u32 v11, v11, 4, v7
    ds_read_b64_tr_b16 v[20:21], v11
    ds_read_b64_tr_b16 v[22:23], v11 offset:5120
    v_add_u32 v11, 4, v9
    v_xor_b32 v11, v11, v8
    v_lshl_add_u32 v11, v11, 4, v7
    ds_read_b64_tr_b16 v[24:25], v11
    ds_read_b64_tr_b16 v[26:27], v11 offset:5120
    v_add_u32 v11, 6, v9
    v_xor_b32 v11, v11, v8
    v_lshl_add_u32 v11, v11, 4, v7
    ds_read_b64_tr_b16 v[28:29], v11
    ds_read_b64_tr_b16 v[30:31], v11 offset:5120
    v_add_u32 v11, 8, v9
    v_xor_b32 v11, v11, v8
    v_lshl_add_u32 v11, v11, 4, v7
    ds_read_b64_tr_b16 v[32:33], v11
    ds_read_b64_tr_b16 v[34:35], v11 offset:5120
    v_add_u32 v11, 10, v9
    v_xor_b32 v11, v11, v8
    v_lshl_add_u32 v11, v11, 4, v7
    ds_read_b64_tr_b16 v[36:37], v11
    ds_read_b64_tr_b16 v[38:39], v11 offset:5120
    v_add_u32 v11, 12, v9
    v_xor_b32 v11, v11, v8
    v_lshl_add_u32 v11, v11, 4, v7
    ds_read_b64_tr_b16 v[40:41], v11
    ds_read_b64_tr_b16 v[42:43], v11 offset:5120
    v_add_u32 v11, 14, v9
    v_xor_b32 v11, v11, v8
    v_lshl_add_u32 v11, v11, 4, v7
    ds_read_b64_tr_b16 v[44:45], v11
    ds_read_b64_tr_b16 v[46:47], v11 offset:5120
    v_add_u32 v11, 16, v9
    v_xor_b32 v11, v11, v8
    v_lshl_add_u32 v11, v11, 4, v7
    ds_read_b64_tr_b16 v[48:49], v11
    ds_read_b64_tr_b16 v[50:51], v11 offset:5120
    v_add_u32 v11, 18, v9
    v_xor_b32 v11, v11, v8
    v_lshl_add_u32 v11, v11, 4, v7
    ds_read_b64_tr_b16 v[52:53], v11
    ds_read_b64_tr_b16 v[54:55], v11 offset:5120
    s_mov_b32 s16, 0
    s_waitcnt lgkmcnt(15)
    buffer_store_dwordx4 v[16:19], v10, s[12:15], s16 offen sc0 sc1
    s_mov_b32 s16, 65536
    s_waitcnt lgkmcnt(15)
    buffer_store_dwordx4 v[20:23], v10, s[12:15], s16 offen sc0 sc1
    s_mov_b32 s16, 131072
    s_waitcnt lgkmcnt(14)
    buffer_store_dwordx4 v[24:27], v10, s[12:15], s16 offen sc0 sc1
    s_mov_b32 s16, 196608
    s_waitcnt lgkmcnt(12)
    buffer_store_dwordx4 v[28:31], v10, s[12:15], s16 offen sc0 sc1
    s_mov_b32 s16, 262144
    s_waitcnt lgkmcnt(10)
    buffer_store_dwordx4 v[32:35], v10, s[12:15], s16 offen sc0 sc1
    s_mov_b32 s16, 327680
    s_waitcnt lgkmcnt(8)
    buffer_store_dwordx4 v[36:39], v10, s[12:15], s16 offen sc0 sc1
    s_mov_b32 s16, 393216
    s_waitcnt lgkmcnt(6)
    buffer_store_dwordx4 v[40:43], v10, s[12:15], s16 offen sc0 sc1
    s_mov_b32 s16, 458752
    s_waitcnt lgkmcnt(4)
    buffer_store_dwordx4 v[44:47], v10, s[12:15], s16 offen sc0 sc1
    s_mov_b32 s16, 524288
    s_waitcnt lgkmcnt(2)
    buffer_store_dwordx4 v[48:51], v10, s[12:15], s16 offen sc0 sc1
    s_mov_b32 s16, 589824
    s_waitcnt lgkmcnt(0)
    buffer_store_dwordx4 v[52:55], v10, s[12:15], s16 offen sc0 sc1
    s_endpgm
L_k1_mod:
    s_load_dwordx2 s[4:5], s[0:1], 96
    s_load_dwordx2 s[8:9], s[0:1], 88
    s_load_dwordx2 s[12:13], s[0:1], 120
    s_sub_u32 s3, s2, 704
    s_lshr_b32 s16, s3, 2
    s_and_b32 s17, s3, 3
    v_lshrrev_b32 v1, 4, v0
    v_and_b32 v2, 15, v0
    v_mul_u32_u24 v4, 7680, v1
    v_lshl_add_u32 v4, v2, 4, v4
    s_mul_i32 s18, s17, 1228800
    s_lshl_b32 s19, s16, 8
    s_add_u32 s18, s18, s19
    s_mul_i32 s19, s17, 320
    v_lshlrev_b32 v5, 1, v1
    v_add_u32 v5, s19, v5
    s_waitcnt lgkmcnt(0)
    s_mov_b32 s6, 4915200
    s_mov_b32 s7, 0x20000
    s_mov_b32 s10, 1280
    s_mov_b32 s11, 0x20000
    s_mov_b32 s14, 61440
    s_mov_b32 s15, 0x20000
    buffer_load_ushort v56, v5, s[8:11], 0 offen offset:0
    buffer_load_ushort v57, v5, s[8:11], 0 offen offset:32
    buffer_load_ushort v58, v5, s[8:11], 0 offen offset:64
    buffer_load_ushort v59, v5, s[8:11], 0 offen offset:96
    buffer_load_ushort v60, v5, s[8:11], 0 offen offset:128
    buffer_load_ushort v61, v5, s[8:11], 0 offen offset:160
    buffer_load_ushort v62, v5, s[8:11], 0 offen offset:192
    buffer_load_ushort v63, v5, s[8:11], 0 offen offset:224
    buffer_load_ushort v64, v5, s[8:11], 0 offen offset:256
    buffer_load_ushort v65, v5, s[8:11], 0 offen offset:288
    buffer_load_dwordx4 v[16:19], v4, s[4:7], s18 offen nt
    s_add_u32 s18, s18, 122880
    buffer_load_dwordx4 v[20:23], v4, s[4:7], s18 offen nt
    s_add_u32 s18, s18, 122880
    buffer_load_dwordx4 v[24:27], v4, s[4:7], s18 offen nt
    s_add_u32 s18, s18, 122880
    buffer_load_dwordx4 v[28:31], v4, s[4:7], s18 offen nt
    s_add_u32 s18, s18, 122880
    buffer_load_dwordx4 v[32:35], v4, s[4:7], s18 offen nt
    s_add_u32 s18, s18, 122880
    buffer_load_dwordx4 v[36:39], v4, s[4:7], s18 offen nt
    s_add_u32 s18, s18, 122880
    buffer_load_dwordx4 v[40:43], v4, s[4:7], s18 offen nt
    s_add_u32 s18, s18, 122880
    buffer_load_dwordx4 v[44:47], v4, s[4:7], s18 offen nt
    s_add_u32 s18, s18, 122880
    buffer_load_dwordx4 v[48:51], v4, s[4:7], s18 offen nt
    s_add_u32 s18, s18, 122880
    buffer_load_dwordx4 v[52:55], v4, s[4:7], s18 offen nt
    s_waitcnt vmcnt(10)
    v_lshlrev_b32 v56, 16, v56
    v_lshlrev_b32 v57, 16, v57
    v_lshlrev_b32 v58, 16, v58
    v_lshlrev_b32 v59, 16, v59
    v_lshlrev_b32 v60, 16, v60
    v_lshlrev_b32 v61, 16, v61
    v_lshlrev_b32 v62, 16, v62
    v_lshlrev_b32 v63, 16, v63
    v_lshlrev_b32 v64, 16, v64
    v_lshlrev_b32 v65, 16, v65
    v_mul_f32 v66, 0xbfb8aa3b, v56
    v_mul_f32 v67, 0xbfb8aa3b, v57
    v_mul_f32 v68, 0xbfb8aa3b, v58
    v_mul_f32 v69, 0xbfb8aa3b, v59
    v_mul_f32 v70, 0xbfb8aa3b, v60
    v_mul_f32 v71, 0xbfb8aa3b, v61
    v_mul_f32 v72, 0xbfb8aa3b, v62
    v_mul_f32 v73, 0xbfb8aa3b, v63
    v_mul_f32 v74, 0xbfb8aa3b, v64
    v_mul_f32 v75, 0xbfb8aa3b, v65
    v_exp_f32 v66, v66
    v_exp_f32 v67, v67
    v_exp_f32 v68, v68
    v_exp_f32 v69, v69
    v_exp_f32 v70, v70
    v_exp_f32 v71, v71
    v_exp_f32 v72, v72
    v_exp_f32 v73, v73
    v_exp_f32 v74, v74
    v_exp_f32 v75, v75
    v_add_f32 v66, 1.0, v66
    v_add_f32 v67, 1.0, v67
    v_add_f32 v68, 1.0, v68
    v_add_f32 v69, 1.0, v69
    v_add_f32 v70, 1.0, v70
    v_add_f32 v71, 1.0, v71
    v_add_f32 v72, 1.0, v72
    v_add_f32 v73, 1.0, v73
    v_add_f32 v74, 1.0, v74
    v_add_f32 v75, 1.0, v75
    v_rcp_f32 v66, v66
    v_rcp_f32 v67, v67
    v_rcp_f32 v68, v68
    v_rcp_f32 v69, v69
    v_rcp_f32 v70, v70
    v_rcp_f32 v71, v71
    v_rcp_f32 v72, v72
    v_rcp_f32 v73, v73
    v_rcp_f32 v74, v74
    v_rcp_f32 v75, v75
    v_mul_f32 v56, v56, v66
    v_mul_f32 v57, v57, v67
    v_mul_f32 v58, v58, v68
    v_mul_f32 v59, v59, v69
    v_mul_f32 v60, v60, v70
    v_mul_f32 v61, v61, v71
    v_mul_f32 v62, v62, v72
    v_mul_f32 v63, v63, v73
    v_mul_f32 v64, v64, v74
    v_mul_f32 v65, v65, v75
    v_cvt_pk_bf16_f32 v56, v56, 0
    v_cvt_pk_bf16_f32 v57, v57, 0
    v_cvt_pk_bf16_f32 v58, v58, 0
    v_cvt_pk_bf16_f32 v59, v59, 0
    v_cvt_pk_bf16_f32 v60, v60, 0
    v_cvt_pk_bf16_f32 v61, v61, 0
    v_cvt_pk_bf16_f32 v62, v62, 0
    v_cvt_pk_bf16_f32 v63, v63, 0
    v_cvt_pk_bf16_f32 v64, v64, 0
    v_cvt_pk_bf16_f32 v65, v65, 0
    v_lshlrev_b32 v66, 16, v56
    v_lshlrev_b32 v67, 16, v57
    v_lshlrev_b32 v68, 16, v58
    v_lshlrev_b32 v69, 16, v59
    v_lshlrev_b32 v70, 16, v60
    v_lshlrev_b32 v71, 16, v61
    v_lshlrev_b32 v72, 16, v62
    v_lshlrev_b32 v73, 16, v63
    v_lshlrev_b32 v74, 16, v64
    v_lshlrev_b32 v75, 16, v65
    s_waitcnt vmcnt(9)
    v_dot2_f32_bf16 v76, v16, v56, 0
    v_dot2_f32_bf16 v77, v16, v66, 0
    v_dot2_f32_bf16 v78, v17, v56, 0
    v_dot2_f32_bf16 v79, v17, v66, 0
    v_dot2_f32_bf16 v80, v18, v56, 0
    v_dot2_f32_bf16 v81, v18, v66, 0
    v_dot2_f32_bf16 v82, v19, v56, 0
    v_dot2_f32_bf16 v83, v19, v66, 0
    s_waitcnt vmcnt(8)
    v_dot2_f32_bf16 v76, v20, v57, v76
    v_dot2_f32_bf16 v77, v20, v67, v77
    v_dot2_f32_bf16 v78, v21, v57, v78
    v_dot2_f32_bf16 v79, v21, v67, v79
    v_dot2_f32_bf16 v80, v22, v57, v80
    v_dot2_f32_bf16 v81, v22, v67, v81
    v_dot2_f32_bf16 v82, v23, v57, v82
    v_dot2_f32_bf16 v83, v23, v67, v83
    s_waitcnt vmcnt(7)
    v_dot2_f32_bf16 v76, v24, v58, v76
    v_dot2_f32_bf16 v77, v24, v68, v77
    v_dot2_f32_bf16 v78, v25, v58, v78
    v_dot2_f32_bf16 v79, v25, v68, v79
    v_dot2_f32_bf16 v80, v26, v58, v80
    v_dot2_f32_bf16 v81, v26, v68, v81
    v_dot2_f32_bf16 v82, v27, v58, v82
    v_dot2_f32_bf16 v83, v27, v68, v83
    s_waitcnt vmcnt(6)
    v_dot2_f32_bf16 v76, v28, v59, v76
    v_dot2_f32_bf16 v77, v28, v69, v77
    v_dot2_f32_bf16 v78, v29, v59, v78
    v_dot2_f32_bf16 v79, v29, v69, v79
    v_dot2_f32_bf16 v80, v30, v59, v80
    v_dot2_f32_bf16 v81, v30, v69, v81
    v_dot2_f32_bf16 v82, v31, v59, v82
    v_dot2_f32_bf16 v83, v31, v69, v83
    s_waitcnt vmcnt(5)
    v_dot2_f32_bf16 v76, v32, v60, v76
    v_dot2_f32_bf16 v77, v32, v70, v77
    v_dot2_f32_bf16 v78, v33, v60, v78
    v_dot2_f32_bf16 v79, v33, v70, v79
    v_dot2_f32_bf16 v80, v34, v60, v80
    v_dot2_f32_bf16 v81, v34, v70, v81
    v_dot2_f32_bf16 v82, v35, v60, v82
    v_dot2_f32_bf16 v83, v35, v70, v83
    s_waitcnt vmcnt(4)
    v_dot2_f32_bf16 v76, v36, v61, v76
    v_dot2_f32_bf16 v77, v36, v71, v77
    v_dot2_f32_bf16 v78, v37, v61, v78
    v_dot2_f32_bf16 v79, v37, v71, v79
    v_dot2_f32_bf16 v80, v38, v61, v80
    v_dot2_f32_bf16 v81, v38, v71, v81
    v_dot2_f32_bf16 v82, v39, v61, v82
    v_dot2_f32_bf16 v83, v39, v71, v83
    s_waitcnt vmcnt(3)
    v_dot2_f32_bf16 v76, v40, v62, v76
    v_dot2_f32_bf16 v77, v40, v72, v77
    v_dot2_f32_bf16 v78, v41, v62, v78
    v_dot2_f32_bf16 v79, v41, v72, v79
    v_dot2_f32_bf16 v80, v42, v62, v80
    v_dot2_f32_bf16 v81, v42, v72, v81
    v_dot2_f32_bf16 v82, v43, v62, v82
    v_dot2_f32_bf16 v83, v43, v72, v83
    s_waitcnt vmcnt(2)
    v_dot2_f32_bf16 v76, v44, v63, v76
    v_dot2_f32_bf16 v77, v44, v73, v77
    v_dot2_f32_bf16 v78, v45, v63, v78
    v_dot2_f32_bf16 v79, v45, v73, v79
    v_dot2_f32_bf16 v80, v46, v63, v80
    v_dot2_f32_bf16 v81, v46, v73, v81
    v_dot2_f32_bf16 v82, v47, v63, v82
    v_dot2_f32_bf16 v83, v47, v73, v83
    s_waitcnt vmcnt(1)
    v_dot2_f32_bf16 v76, v48, v64, v76
    v_dot2_f32_bf16 v77, v48, v74, v77
    v_dot2_f32_bf16 v78, v49, v64, v78
    v_dot2_f32_bf16 v79, v49, v74, v79
    v_dot2_f32_bf16 v80, v50, v64, v80
    v_dot2_f32_bf16 v81, v50, v74, v81
    v_dot2_f32_bf16 v82, v51, v64, v82
    v_dot2_f32_bf16 v83, v51, v74, v83
    s_waitcnt vmcnt(0)
    v_dot2_f32_bf16 v76, v52, v65, v76
    v_dot2_f32_bf16 v77, v52, v75, v77
    v_dot2_f32_bf16 v78, v53, v65, v78
    v_dot2_f32_bf16 v79, v53, v75, v79
    v_dot2_f32_bf16 v80, v54, v65, v80
    v_dot2_f32_bf16 v81, v54, v75, v81
    v_dot2_f32_bf16 v82, v55, v65, v82
    v_dot2_f32_bf16 v83, v55, v75, v83
    v_lshlrev_b32 v6, 5, v0
    ds_write_b128 v6, v[76:79]
    s_nop 0
    ds_write_b128 v6, v[80:83] offset:16
    s_waitcnt lgkmcnt(0)
    s_barrier
    v_cmp_gt_u32 vcc, 128, v0
    s_nop 3
    s_and_saveexec_b64 s[20:21], vcc
    s_cbranch_execz L_k1_mod_end
    v_lshlrev_b32 v6, 2, v0
    ds_read_b32 v16, v6 offset:0
    ds_read_b32 v17, v6 offset:512
    ds_read_b32 v18, v6 offset:1024
    ds_read_b32 v19, v6 offset:1536
    ds_read_b32 v20, v6 offset:2048
    ds_read_b32 v21, v6 offset:2560
    ds_read_b32 v22, v6 offset:3072
    ds_read_b32 v23, v6 offset:3584
    ds_read_b32 v24, v6 offset:4096
    ds_read_b32 v25, v6 offset:4608
    ds_read_b32 v26, v6 offset:5120
    ds_read_b32 v27, v6 offset:5632
    ds_read_b32 v28, v6 offset:6144
    ds_read_b32 v29, v6 offset:6656
    ds_read_b32 v30, v6 offset:7168
    ds_read_b32 v31, v6 offset:7680
    s_waitcnt lgkmcnt(0)
    v_add_f32 v16, v16, v24
    v_add_f32 v17, v17, v25
    v_add_f32 v18, v18, v26
    v_add_f32 v19, v19, v27
    v_add_f32 v20, v20, v28
    v_add_f32 v21, v21, v29
    v_add_f32 v22, v22, v30
    v_add_f32 v23, v23, v31
    v_add_f32 v16, v16, v20
    v_add_f32 v17, v17, v21
    v_add_f32 v18, v18, v22
    v_add_f32 v19, v19, v23
    v_add_f32 v16, v16, v18
    v_add_f32 v17, v17, v19
    v_add_f32 v16, v16, v17
    s_mul_i32 s19, s17, 15360
    s_lshl_b32 s22, s16, 9
    s_add_u32 s19, s19, s22
    buffer_store_dword v16, v6, s[12:15], s19 offen sc0 sc1
L_k1_mod_end:
    s_mov_b64 exec, s[20:21]
    s_endpgm
L_k1_pf:
    s_load_dwordx2 s[8:9], s[0:1], 120
    s_sub_u32 s3, s2, 824
    s_getpc_b64 s[28:29]
L_k1_pc2:
    s_add_u32 s28, s28, conv_kernel-L_k1_pc2
    s_addc_u32 s29, s29, 0
    s_mov_b32 s30, code_end-conv_kernel
    s_mov_b32 s31, 0x20000
    v_lshlrev_b32 v4, 4, v0
    s_mov_b32 s27, 0
    buffer_load_dwordx4 v[64:67], v4, s[28:31], s27 offen
    s_mov_b32 s27, 4096
    buffer_load_dwordx4 v[68:71], v4, s[28:31], s27 offen
    s_mov_b32 s27, 8192
    buffer_load_dwordx4 v[72:75], v4, s[28:31], s27 offen
    s_mov_b32 s27, 12288
    buffer_load_dwordx4 v[76:79], v4, s[28:31], s27 offen
    s_mov_b32 s27, 16384
    buffer_load_dwordx4 v[80:83], v4, s[28:31], s27 offen
    s_mov_b32 s27, 20480
    buffer_load_dwordx4 v[84:87], v4, s[28:31], s27 offen
    s_mov_b32 s27, 24576
    buffer_load_dwordx4 v[88:91], v4, s[28:31], s27 offen
    s_mov_b32 s27, 28672
    buffer_load_dwordx4 v[92:95], v4, s[28:31], s27 offen
    s_mov_b32 s27, 32768
    buffer_load_dwordx4 v[96:99], v4, s[28:31], s27 offen
    s_mov_b32 s27, 36864
    buffer_load_dwordx4 v[100:103], v4, s[28:31], s27 offen
    s_mov_b32 s27, 40960
    buffer_load_dwordx4 v[104:107], v4, s[28:31], s27 offen
    v_mov_b32 v8, 0
    v_mov_b32 v9, 0
    v_mov_b32 v10, 0
    v_mov_b32 v11, 0
    s_waitcnt lgkmcnt(0)
    s_add_u32 s20, s8, 18350080
    s_addc_u32 s21, s9, 0
    s_mov_b32 s22, 2555904
    s_mov_b32 s23, 0x20000
    s_cmp_lg_u32 s3, 0
    s_cbranch_scc1 L_k1_pf_nz
    buffer_store_dwordx4 v[8:11], v4, s[20:23], 0 offen sc0 sc1
L_k1_pf_nz:
    s_mul_i32 s26, s3, 20480
    s_add_u32 s26, s26, 2228224
    buffer_store_dwordx4 v[8:11], v4, s[20:23], s26 offen sc0 sc1
    s_add_u32 s26, s26, 4096
    buffer_store_dwordx4 v[8:11], v4, s[20:23], s26 offen sc0 sc1
    s_add_u32 s26, s26, 4096
    buffer_store_dwordx4 v[8:11], v4, s[20:23], s26 offen sc0 sc1
    s_add_u32 s26, s26, 4096
    buffer_store_dwordx4 v[8:11], v4, s[20:23], s26 offen sc0 sc1
    s_add_u32 s26, s26, 4096
    buffer_store_dwordx4 v[8:11], v4, s[20:23], s26 offen sc0 sc1
    s_endpgm

.globl conv_kernel
.p2align 8
.type conv_kernel,@function
conv_kernel:
    s_cmp_lt_u32 s2, 640
    s_cbranch_scc1 L_k2_cv
    s_cmp_lt_u32 s2, 760
    s_cbranch_scc1 L_k2_wp
    s_cmp_lt_u32 s2, 808
    s_cbranch_scc1 L_k2_wd
    s_endpgm
L_k2_cv:
    s_setprio 1
    s_load_dwordx2 s[4:5], s[0:1], 120
    s_load_dwordx2 s[20:21], s[0:1], 48
    s_sub_u32 s3, s2, 0
    s_and_b32 s24, s3, 0xffffffe0
    s_and_b32 s25, s3, 7
    s_lshl_b32 s25, s25, 2
    s_or_b32 s24, s24, s25
    s_lshr_b32 s25, s3, 3
    s_and_b32 s25, s25, 3
    s_or_b32 s3, s24, s25
    v_lshlrev_b32 v1, 6, v0
    s_and_b32 s24, s3, 3
    s_lshl_b32 s24, s24, 4
    v_add_u32 v1, s24, v1
    v_lshlrev_b32 v2, 5, v0
    v_lshlrev_b32 v3, 4, v0
    s_lshr_b32 s25, s3, 2
    s_lshl_b32 s25, s25, 14
    s_lshl_b32 s26, s3, 12
    s_lshl_b32 s27, s3, 2
    s_lshr_b32 s28, s3, 1
    s_lshl_b32 s28, s28, 2
    s_waitcnt lgkmcnt(0)
    s_add_u32 s30, s4, s27
    s_addc_u32 s31, s5, 0
    s_load_dword s40, s[30:31], 0
    s_load_dword s44, s[30:31], 2560
    s_load_dword s48, s[30:31], 5120
    s_load_dword s41, s[30:31], 15360
    s_load_dword s45, s[30:31], 17920
    s_load_dword s49, s[30:31], 20480
    s_load_dword s42, s[30:31], 30720
    s_load_dword s46, s[30:31], 33280
    s_load_dword s50, s[30:31], 35840
    s_load_dword s43, s[30:31], 46080
    s_load_dword s47, s[30:31], 48640
    s_load_dword s51, s[30:31], 51200
    s_add_u32 s20, s20, s28
    s_addc_u32 s21, s21, 0
    s_load_dword s52, s[20:21], 0
    s_add_u32 s8, s4, 262144
    s_addc_u32 s9, s5, 0
    s_mov_b32 s10, 2621440
    s_mov_b32 s11, 0x20000
    s_add_u32 s12, s4, 65536
    s_addc_u32 s13, s5, 0
    s_mov_b32 s14, 8192
    s_mov_b32 s15, 0x20000
    s_add_u32 s16, s4, 2883584
    s_addc_u32 s17, s5, 0
    s_add_u32 s16, s16, s26
    s_addc_u32 s17, s17, 0
    s_mov_b32 s18, 4096
    s_mov_b32 s19, 0x20000
    buffer_load_dwordx4 v[8:11], v3, s[16:19], 0 offen
    buffer_load_dwordx4 v[12:15], v3, s[16:19], 0 offen offset:4
    buffer_load_dwordx4 v[16:19], v3, s[16:19], 0 offen offset:8
    buffer_load_dwordx4 v[20:23], v1, s[8:11], s25 offen
    buffer_load_dwordx4 v[24:27], v2, s[12:15], 0 offen
    buffer_load_dwordx4 v[28:31], v2, s[12:15], 0 offen offset:16
    s_add_u32 s32, s4, 5505024
    s_addc_u32 s33, s5, 0
    s_mov_b32 s34, 2621440
    s_mov_b32 s35, 0x20000
    v_mov_b32 v32, 0
    v_mov_b32 v33, 0
    v_mov_b32 v34, 0
    v_mov_b32 v35, 0
    v_lshrrev_b32 v4, 2, v0
    v_and_b32 v5, 3, v0
    v_mul_u32_u24 v6, 96, v4
    v_lshl_add_u32 v6, v5, 4, v6
    v_mul_u32_u24 v7, 4160, v4
    v_lshl_add_u32 v7, v5, 4, v7
    v_cmp_gt_u32 vcc, 128, v0
    s_nop 3
    s_and_saveexec_b64 s[36:37], vcc
    ds_write_b128 v6, v[32:35] offset:16640
    v_cmp_gt_u32 vcc, 16, v0
    s_nop 3
    s_and_b64 exec, exec, vcc
    ds_write_b128 v7, v[32:35] offset:4096
    s_mov_b64 exec, s[36:37]
    v_and_b32 v36, 63, v0
    v_lshrrev_b32 v37, 6, v0
    v_and_b32 v38, 31, v36
    v_lshrrev_b32 v39, 5, v36
    v_sub_u32 v40, 3, v38
    v_and_b32 v40, 3, v40
    v_mul_u32_u24 v41, 4160, v40
    v_sub_u32 v42, 2047, v38
    v_lshl_add_u32 v42, v39, 3, v42
    v_sub_u32 v42, v42, v40
    v_lshl_add_u32 v41, v42, 1, v41
    v_lshlrev_b32 v42, 9, v37
    v_sub_u32 v41, v41, v42
    v_subrev_u32 v41, 2496, v41
    v_lshlrev_b32 v42, 3, v37
    v_sub_u32 v42, v38, v42
    v_add_u32 v42, 25, v42
    v_mul_u32_u24 v42, 80, v42
    v_lshl_add_u32 v42, v39, 4, v42
    v_add_u32 v42, 16640, v42
    v_mul_u32_u24 v43, 9216, v37
    v_mul_u32_u24 v44, 144, v38
    v_add_u32 v43, v43, v44
    v_lshl_add_u32 v43, v39, 4, v43
    v_mul_u32_u24 v44, 144, v4
    v_lshl_add_u32 v44, v5, 5, v44
    v_and_b32 v38, 15, v36
    v_lshrrev_b32 v39, 4, v36
    v_readfirstlane_b32 s54, v37
    v_sub_u32 v40, 3, v38
    v_and_b32 v40, 3, v40
    v_mul_u32_u24 v41, 4160, v40
    v_sub_u32 v42, 2047, v38
    v_lshl_add_u32 v42, v39, 3, v42
    v_sub_u32 v42, v42, v40
    v_lshl_add_u32 v41, v42, 1, v41
    s_mov_b32 s55, 6
    s_cmp_eq_u32 s54, 1
    s_cselect_b32 s55, 13, s55
    s_cmp_eq_u32 s54, 2
    s_cselect_b32 s55, 21, s55
    s_cmp_eq_u32 s54, 3
    s_cselect_b32 s55, 31, s55
    s_add_u32 s56, s55, 32
    s_lshl_b32 s56, s56, 6
    s_add_u32 s56, s56, 32
    v_subrev_u32 v1, s56, v41
    v_add_u32 v42, 32, v38
    v_subrev_u32 v42, s55, v42
    v_mul_u32_u24 v42, 96, v42
    v_lshl_add_u32 v42, v39, 4, v42
    v_add_u32 v2, 16640, v42
    v_mul_u32_u24 v4, 9216, v37
    v_mul_u32_u24 v42, 144, v38
    v_add_u32 v4, v4, v42
    v_lshl_add_u32 v4, v39, 4, v4
    v_mov_b32 v5, v44
    s_waitcnt lgkmcnt(0)
    v_mov_b32 v45, s40
    v_add_f32 v45, s41, v45
    v_add_f32 v45, s42, v45
    v_add_f32 v45, s43, v45
    v_mov_b32 v46, s44
    v_add_f32 v46, s45, v46
    v_add_f32 v46, s46, v46
    v_add_f32 v46, s47, v46
    v_mov_b32 v47, s48
    v_add_f32 v47, s49, v47
    v_add_f32 v47, s50, v47
    v_add_f32 v47, s51, v47
    v_cvt_pk_bf16_f32 v45, v45, v46
    v_cvt_pk_bf16_f32 v47, v47, v47
    v_and_b32 v46, 0xffff0000, v45
    v_lshlrev_b32 v45, 16, v45
    v_lshlrev_b32 v47, 16, v47
    v_add_f32 v46, 1.0, v46
    v_cvt_pk_bf16_f32 v46, v46, v46
    v_lshlrev_b32 v46, 16, v46
    s_and_b32 s53, s3, 1
    s_lshl_b32 s53, s53, 4
    s_lshr_b32 s52, s52, s53
    s_lshl_b32 s52, s52, 16
    s_waitcnt vmcnt(3)
    ds_write_b128 v3, v[8:11]
    ds_write_b128 v3, v[12:15] offset:8320
    v_alignbit_b32 v48, v12, v8, 16
    v_alignbit_b32 v49, v13, v9, 16
    v_alignbit_b32 v50, v14, v10, 16
    v_alignbit_b32 v51, v15, v11, 16
    v_alignbit_b32 v52, v16, v12, 16
    v_alignbit_b32 v53, v17, v13, 16
    v_alignbit_b32 v54, v18, v14, 16
    v_alignbit_b32 v55, v19, v15, 16
    ds_write_b128 v3, v[48:51] offset:4160
    ds_write_b128 v3, v[52:55] offset:12480
    s_waitcnt vmcnt(0)
    v_and_b32 v56, 0xffff0000, v24
    v_and_b32 v57, 0xffff0000, v25
    v_and_b32 v58, 0xffff0000, v26
    v_and_b32 v59, 0xffff0000, v27
    v_and_b32 v60, 0xffff0000, v28
    v_and_b32 v61, 0xffff0000, v29
    v_and_b32 v62, 0xffff0000, v30
    v_and_b32 v63, 0xffff0000, v31
    v_rcp_f32 v56, v56
    v_rcp_f32 v57, v57
    v_rcp_f32 v58, v58
    v_rcp_f32 v59, v59
    v_rcp_f32 v60, v60
    v_rcp_f32 v61, v61
    v_rcp_f32 v62, v62
    v_rcp_f32 v63, v63
    v_lshlrev_b32 v24, 16, v24
    v_lshlrev_b32 v25, 16, v25
    v_lshlrev_b32 v26, 16, v26
    v_lshlrev_b32 v27, 16, v27
    v_lshlrev_b32 v28, 16, v28
    v_lshlrev_b32 v29, 16, v29
    v_lshlrev_b32 v30, 16, v30
    v_lshlrev_b32 v31, 16, v31
    v_lshlrev_b32 v64, 16, v20
    v_and_b32 v65, 0xffff0000, v20
    v_lshlrev_b32 v66, 16, v21
    v_and_b32 v67, 0xffff0000, v21
    v_lshlrev_b32 v68, 16, v22
    v_and_b32 v69, 0xffff0000, v22
    v_lshlrev_b32 v70, 16, v23
    v_and_b32 v71, 0xffff0000, v23
    v_sub_f32 v64, v64, v24
    v_sub_f32 v65, v65, v25
    v_sub_f32 v66, v66, v26
    v_sub_f32 v67, v67, v27
    v_sub_f32 v68, v68, v28
    v_sub_f32 v69, v69, v29
    v_sub_f32 v70, v70, v30
    v_sub_f32 v71, v71, v31
    v_mul_f32 v64, v64, v56
    v_mul_f32 v65, v65, v57
    v_mul_f32 v66, v66, v58
    v_mul_f32 v67, v67, v59
    v_mul_f32 v68, v68, v60
    v_mul_f32 v69, v69, v61
    v_mul_f32 v70, v70, v62
    v_mul_f32 v71, v71, v63
    v_fma_f32 v64, v64, v46, v45
    v_fma_f32 v65, v65, v46, v45
    v_fma_f32 v66, v66, v46, v45
    v_fma_f32 v67, v67, v46, v45
    v_fma_f32 v68, v68, v46, v45
    v_fma_f32 v69, v69, v46, v45
    v_fma_f32 v70, v70, v46, v45
    v_fma_f32 v71, v71, v46, v45
    v_cvt_pk_bf16_f32 v8, v64, v65
    v_cvt_pk_bf16_f32 v9, v66, v67
    v_cvt_pk_bf16_f32 v10, v68, v69
    v_cvt_pk_bf16_f32 v11, v70, v71
    ds_write_b128 v6, v[8:11] offset:19712
    v_mov_b32 v16, v47
    s_waitcnt lgkmcnt(0)
    s_barrier
    s_setprio 0
    s_cmp_lg_u32 s54, 0
    s_cbranch_scc1 L_cv16_w1
    ds_read_b64 v[32:33], v1 offset:2464
    ds_read_b64 v[34:35], v1 offset:2472
    ds_read_b128 v[56:59], v2 offset:3648
    ds_read_b128 v[60:63], v2 offset:5184
    ds_read_b64 v[36:37], v1 offset:2432
    ds_read_b64 v[38:39], v1 offset:2440
    ds_read_b128 v[52:55], v2 offset:2112
    ds_read_b128 v[48:51], v2 offset:576
    ds_read_b64 v[40:41], v1 offset:416
    ds_read_b64 v[42:43], v1 offset:424
    ds_read_b64 v[44:45], v1 offset:384
    ds_read_b64 v[46:47], v1 offset:392
    s_waitcnt lgkmcnt(10)
    s_waitcnt lgkmcnt(9)
    v_mfma_f32_16x16x32_bf16 v[104:107], v[32:35], v[56:59], 0
    ds_read_b64 v[64:65], v1 offset:2400
    s_waitcnt lgkmcnt(9)
    v_mfma_f32_16x16x32_bf16 v[108:111], v[32:35], v[60:63], 0
    ds_read_b64 v[66:67], v1 offset:2408
    s_waitcnt lgkmcnt(8)
    v_mfma_f32_16x16x32_bf16 v[120:123], v[36:39], v[56:59], 0
    ds_read_b128 v[88:91], v2 offset:3552
    v_mfma_f32_16x16x32_bf16 v[124:127], v[36:39], v[60:63], 0
    ds_read_b128 v[92:95], v2 offset:5088
    s_waitcnt lgkmcnt(9)
    v_mfma_f32_16x16x32_bf16 v[100:103], v[32:35], v[52:55], 0
    ds_read_b64 v[68:69], v1 offset:2368
    v_mfma_f32_16x16x32_bf16 v[116:119], v[36:39], v[52:55], 0
    ds_read_b64 v[70:71], v1 offset:2376
    s_waitcnt lgkmcnt(10)
    v_mfma_f32_16x16x32_bf16 v[96:99], v[32:35], v[48:51], 0
    ds_read_b128 v[84:87], v2 offset:2016
    v_mfma_f32_16x16x32_bf16 v[112:115], v[36:39], v[48:51], 0
    ds_read_b128 v[80:83], v2 offset:480
    s_waitcnt lgkmcnt(10)
    v_mfma_f32_16x16x32_bf16 v[108:111], v[40:43], v[52:55], v[108:111]
    ds_read_b64 v[72:73], v1 offset:352
    s_waitcnt lgkmcnt(9)
    v_mfma_f32_16x16x32_bf16 v[124:127], v[44:47], v[52:55], v[124:127]
    ds_read_b64 v[74:75], v1 offset:360
    v_mfma_f32_16x16x32_bf16 v[104:107], v[40:43], v[48:51], v[104:107]
    ds_read_b64 v[76:77], v1 offset:320
    v_mfma_f32_16x16x32_bf16 v[120:123], v[44:47], v[48:51], v[120:123]
    ds_read_b64 v[78:79], v1 offset:328
    s_waitcnt lgkmcnt(10)
    s_waitcnt lgkmcnt(9)
    v_mfma_f32_16x16x32_bf16 v[104:107], v[64:67], v[88:91], v[104:107]
    ds_read_b64 v[32:33], v1 offset:2336
    s_waitcnt lgkmcnt(9)
    v_mfma_f32_16x16x32_bf16 v[108:111], v[64:67], v[92:95], v[108:111]
    ds_read_b64 v[34:35], v1 offset:2344
    s_waitcnt lgkmcnt(8)
    v_mfma_f32_16x16x32_bf16 v[120:123], v[68:71], v[88:91], v[120:123]
    ds_read_b128 v[56:59], v2 offset:3456
    v_mfma_f32_16x16x32_bf16 v[124:127], v[68:71], v[92:95], v[124:127]
    ds_read_b128 v[60:63], v2 offset:4992
    s_waitcnt lgkmcnt(9)
    v_mfma_f32_16x16x32_bf16 v[100:103], v[64:67], v[84:87], v[100:103]
    ds_read_b64 v[36:37], v1 offset:2304
    v_mfma_f32_16x16x32_bf16 v[116:119], v[68:71], v[84:87], v[116:119]
    ds_read_b64 v[38:39], v1 offset:2312
    s_waitcnt lgkmcnt(10)
    v_mfma_f32_16x16x32_bf16 v[96:99], v[64:67], v[80:83], v[96:99]
    ds_read_b128 v[52:55], v2 offset:1920
    v_mfma_f32_16x16x32_bf16 v[112:115], v[68:71], v[80:83], v[112:115]
    ds_read_b128 v[48:51], v2 offset:384
    s_waitcnt lgkmcnt(10)
    v_mfma_f32_16x16x32_bf16 v[108:111], v[72:75], v[84:87], v[108:111]
    ds_read_b64 v[40:41], v1 offset:288
    s_waitcnt lgkmcnt(9)
    v_mfma_f32_16x16x32_bf16 v[124:127], v[76:79], v[84:87], v[124:127]
    ds_read_b64 v[42:43], v1 offset:296
    v_mfma_f32_16x16x32_bf16 v[104:107], v[72:75], v[80:83], v[104:107]
    ds_read_b64 v[44:45], v1 offset:256
    v_mfma_f32_16x16x32_bf16 v[120:123], v[76:79], v[80:83], v[120:123]
    ds_read_b64 v[46:47], v1 offset:264
    s_waitcnt lgkmcnt(10)
    s_waitcnt lgkmcnt(9)
    v_mfma_f32_16x16x32_bf16 v[104:107], v[32:35], v[56:59], v[104:107]
    ds_read_b64 v[64:65], v1 offset:2272
    s_waitcnt lgkmcnt(9)
    v_mfma_f32_16x16x32_bf16 v[108:111], v[32:35], v[60:63], v[108:111]
    ds_read_b64 v[66:67], v1 offset:2280
    s_waitcnt lgkmcnt(8)
    v_mfma_f32_16x16x32_bf16 v[120:123], v[36:39], v[56:59], v[120:123]
    ds_read_b128 v[88:91], v2 offset:3360
    v_mfma_f32_16x16x32_bf16 v[124:127], v[36:39], v[60:63], v[124:127]
    ds_read_b128 v[92:95], v2 offset:4896
    s_waitcnt lgkmcnt(9)
    v_mfma_f32_16x16x32_bf16 v[100:103], v[32:35], v[52:55], v[100:103]
    ds_read_b64 v[68:69], v1 offset:2240
    v_mfma_f32_16x16x32_bf16 v[116:119], v[36:39], v[52:55], v[116:119]
    ds_read_b64 v[70:71], v1 offset:2248
    s_waitcnt lgkmcnt(10)
    v_mfma_f32_16x16x32_bf16 v[96:99], v[32:35], v[48:51], v[96:99]
    ds_read_b128 v[84:87], v2 offset:1824
    v_mfma_f32_16x16x32_bf16 v[112:115], v[36:39], v[48:51], v[112:115]
    ds_read_b128 v[80:83], v2 offset:288
    s_waitcnt lgkmcnt(10)
    v_mfma_f32_16x16x32_bf16 v[108:111], v[40:43], v[52:55], v[108:111]
    ds_read_b64 v[72:73], v1 offset:224
    s_waitcnt lgkmcnt(9)
    v_mfma_f32_16x16x32_bf16 v[124:127], v[44:47], v[52:55], v[124:127]
    ds_read_b64 v[74:75], v1 offset:232
    v_mfma_f32_16x16x32_bf16 v[104:107], v[40:43], v[48:51], v[104:107]
    ds_read_b64 v[76:77], v1 offset:192
    v_mfma_f32_16x16x32_bf16 v[120:123], v[44:47], v[48:51], v[120:123]
    ds_read_b64 v[78:79], v1 offset:200
    s_waitcnt lgkmcnt(10)
    s_waitcnt lgkmcnt(9)
    v_mfma_f32_16x16x32_bf16 v[104:107], v[64:67], v[88:91], v[104:107]
    ds_read_b64 v[32:33], v1 offset:2208
    s_waitcnt lgkmcnt(9)
    v_mfma_f32_16x16x32_bf16 v[108:111], v[64:67], v[92:95], v[108:111]
    ds_read_b64 v[34:35], v1 offset:2216
    s_waitcnt lgkmcnt(8)
    v_mfma_f32_16x16x32_bf16 v[120:123], v[68:71], v[88:91], v[120:123]
    ds_read_b128 v[56:59], v2 offset:3264
    v_mfma_f32_16x16x32_bf16 v[124:127], v[68:71], v[92:95], v[124:127]
    ds_read_b128 v[60:63], v2 offset:4800
    s_waitcnt lgkmcnt(9)
    v_mfma_f32_16x16x32_bf16 v[100:103], v[64:67], v[84:87], v[100:103]
    ds_read_b64 v[36:37], v1 offset:2176
    v_mfma_f32_16x16x32_bf16 v[116:119], v[68:71], v[84:87], v[116:119]
    ds_read_b64 v[38:39], v1 offset:2184
    s_waitcnt lgkmcnt(10)
    v_mfma_f32_16x16x32_bf16 v[96:99], v[64:67], v[80:83], v[96:99]
    ds_read_b128 v[52:55], v2 offset:1728
    v_mfma_f32_16x16x32_bf16 v[112:115], v[68:71], v[80:83], v[112:115]
    ds_read_b128 v[48:51], v2 offset:192
    s_waitcnt lgkmcnt(10)
    v_mfma_f32_16x16x32_bf16 v[108:111], v[72:75], v[84:87], v[108:111]
    ds_read_b64 v[40:41], v1 offset:160
    s_waitcnt lgkmcnt(9)
    v_mfma_f32_16x16x32_bf16 v[124:127], v[76:79], v[84:87], v[124:127]
    ds_read_b64 v[42:43], v1 offset:168
    v_mfma_f32_16x16x32_bf16 v[104:107], v[72:75], v[80:83], v[104:107]
    ds_read_b64 v[44:45], v1 offset:128
    v_mfma_f32_16x16x32_bf16 v[120:123], v[76:79], v[80:83], v[120:123]
    ds_read_b64 v[46:47], v1 offset:136
    s_waitcnt lgkmcnt(10)
    s_waitcnt lgkmcnt(9)
    v_mfma_f32_16x16x32_bf16 v[104:107], v[32:35], v[56:59], v[104:107]
    ds_read_b64 v[64:65], v1 offset:2144
    s_waitcnt lgkmcnt(9)
    v_mfma_f32_16x16x32_bf16 v[108:111], v[32:35], v[60:63], v[108:111]
    ds_read_b64 v[66:67], v1 offset:2152
    s_waitcnt lgkmcnt(8)
    v_mfma_f32_16x16x32_bf16 v[120:123], v[36:39], v[56:59], v[120:123]
    ds_read_b128 v[88:91], v2 offset:3168
    v_mfma_f32_16x16x32_bf16 v[124:127], v[36:39], v[60:63], v[124:127]
    ds_read_b128 v[92:95], v2 offset:4704
    s_waitcnt lgkmcnt(9)
    v_mfma_f32_16x16x32_bf16 v[100:103], v[32:35], v[52:55], v[100:103]
    ds_read_b64 v[68:69], v1 offset:2112
    v_mfma_f32_16x16x32_bf16 v[116:119], v[36:39], v[52:55], v[116:119]
    ds_read_b64 v[70:71], v1 offset:2120
    s_waitcnt lgkmcnt(10)
    v_mfma_f32_16x16x32_bf16 v[96:99], v[32:35], v[48:51], v[96:99]
    ds_read_b128 v[84:87], v2 offset:1632
    v_mfma_f32_16x16x32_bf16 v[112:115], v[36:39], v[48:51], v[112:115]
    ds_read_b128 v[80:83], v2 offset:96
    s_waitcnt lgkmcnt(10)
    v_mfma_f32_16x16x32_bf16 v[108:111], v[40:43], v[52:55], v[108:111]
    ds_read_b64 v[72:73], v1 offset:96
    s_waitcnt lgkmcnt(9)
    v_mfma_f32_16x16x32_bf16 v[124:127], v[44:47], v[52:55], v[124:127]
    ds_read_b64 v[74:75], v1 offset:104
    v_mfma_f32_16x16x32_bf16 v[104:107], v[40:43], v[48:51], v[104:107]
    ds_read_b64 v[76:77], v1 offset:64
    v_mfma_f32_16x16x32_bf16 v[120:123], v[44:47], v[48:51], v[120:123]
    ds_read_b64 v[78:79], v1 offset:72
    s_waitcnt lgkmcnt(10)
    s_waitcnt lgkmcnt(9)
    v_mfma_f32_16x16x32_bf16 v[104:107], v[64:67], v[88:91], v[104:107]
    ds_read_b64 v[32:33], v1 offset:2080
    s_waitcnt lgkmcnt(9)
    v_mfma_f32_16x16x32_bf16 v[108:111], v[64:67], v[92:95], v[108:111]
    ds_read_b64 v[34:35], v1 offset:2088
    s_waitcnt lgkmcnt(8)
    v_mfma_f32_16x16x32_bf16 v[120:123], v[68:71], v[88:91], v[120:123]
    ds_read_b128 v[56:59], v2 offset:3072
    v_mfma_f32_16x16x32_bf16 v[124:127], v[68:71], v[92:95], v[124:127]
    ds_read_b128 v[60:63], v2 offset:4608
    s_waitcnt lgkmcnt(9)
    v_mfma_f32_16x16x32_bf16 v[100:103], v[64:67], v[84:87], v[100:103]
    ds_read_b64 v[36:37], v1 offset:2048
    v_mfma_f32_16x16x32_bf16 v[116:119], v[68:71], v[84:87], v[116:119]
    ds_read_b64 v[38:39], v1 offset:2056
    s_waitcnt lgkmcnt(10)
    v_mfma_f32_16x16x32_bf16 v[96:99], v[64:67], v[80:83], v[96:99]
    ds_read_b128 v[52:55], v2 offset:1536
    v_mfma_f32_16x16x32_bf16 v[112:115], v[68:71], v[80:83], v[112:115]
    ds_read_b128 v[48:51], v2 offset:0
    s_waitcnt lgkmcnt(10)
    v_mfma_f32_16x16x32_bf16 v[108:111], v[72:75], v[84:87], v[108:111]
    ds_read_b64 v[40:41], v1 offset:32
    s_waitcnt lgkmcnt(9)
    v_mfma_f32_16x16x32_bf16 v[124:127], v[76:79], v[84:87], v[124:127]
    ds_read_b64 v[42:43], v1 offset:40
    v_mfma_f32_16x16x32_bf16 v[104:107], v[72:75], v[80:83], v[104:107]
    ds_read_b64 v[44:45], v1 offset:0
    v_mfma_f32_16x16x32_bf16 v[120:123], v[76:79], v[80:83], v[120:123]
    ds_read_b64 v[46:47], v1 offset:8
    s_waitcnt lgkmcnt(10)
    s_waitcnt lgkmcnt(9)
    v_mfma_f32_16x16x32_bf16 v[104:107], v[32:35], v[56:59], v[104:107]
    s_waitcnt lgkmcnt(8)
    v_mfma_f32_16x16x32_bf16 v[108:111], v[32:35], v[60:63], v[108:111]
    s_waitcnt lgkmcnt(6)
    v_mfma_f32_16x16x32_bf16 v[120:123], v[36:39], v[56:59], v[120:123]
    v_mfma_f32_16x16x32_bf16 v[124:127], v[36:39], v[60:63], v[124:127]
    s_waitcnt lgkmcnt(5)
    v_mfma_f32_16x16x32_bf16 v[100:103], v[32:35], v[52:55], v[100:103]
    v_mfma_f32_16x16x32_bf16 v[116:119], v[36:39], v[52:55], v[116:119]
    s_waitcnt lgkmcnt(4)
    v_mfma_f32_16x16x32_bf16 v[96:99], v[32:35], v[48:51], v[96:99]
    v_mfma_f32_16x16x32_bf16 v[112:115], v[36:39], v[48:51], v[112:115]
    s_waitcnt lgkmcnt(2)
    v_mfma_f32_16x16x32_bf16 v[108:111], v[40:43], v[52:55], v[108:111]
    s_waitcnt lgkmcnt(0)
    v_mfma_f32_16x16x32_bf16 v[124:127], v[44:47], v[52:55], v[124:127]
    v_mfma_f32_16x16x32_bf16 v[104:107], v[40:43], v[48:51], v[104:107]
    v_mfma_f32_16x16x32_bf16 v[120:123], v[44:47], v[48:51], v[120:123]
    s_branch L_cv16_done
L_cv16_w1:
    s_cmp_lg_u32 s54, 1
    s_cbranch_scc1 L_cv16_w2
    ds_read_b64 v[32:33], v1 offset:2464
    ds_read_b64 v[34:35], v1 offset:2472
    ds_read_b128 v[56:59], v2 offset:3648
    ds_read_b128 v[60:63], v2 offset:5184
    ds_read_b64 v[36:37], v1 offset:2432
    ds_read_b64 v[38:39], v1 offset:2440
    ds_read_b128 v[52:55], v2 offset:2112
    ds_read_b128 v[48:51], v2 offset:576
    ds_read_b64 v[40:41], v1 offset:416
    ds_read_b64 v[42:43], v1 offset:424
    ds_read_b64 v[44:45], v1 offset:384
    ds_read_b64 v[46:47], v1 offset:392
    s_waitcnt lgkmcnt(10)
    s_waitcnt lgkmcnt(9)
    v_mfma_f32_16x16x32_bf16 v[104:107], v[32:35], v[56:59], 0
    ds_read_b64 v[64:65], v1 offset:2400
    s_waitcnt lgkmcnt(9)
    v_mfma_f32_16x16x32_bf16 v[108:111], v[32:35], v[60:63], 0
    ds_read_b64 v[66:67], v1 offset:2408
    s_waitcnt lgkmcnt(8)
    v_mfma_f32_16x16x32_bf16 v[120:123], v[36:39], v[56:59], 0
    ds_read_b128 v[88:91], v2 offset:3552
    v_mfma_f32_16x16x32_bf16 v[124:127], v[36:39], v[60:63], 0
    ds_read_b128 v[92:95], v2 offset:5088
    s_waitcnt lgkmcnt(9)
    v_mfma_f32_16x16x32_bf16 v[100:103], v[32:35], v[52:55], 0
    ds_read_b64 v[68:69], v1 offset:2368
    v_mfma_f32_16x16x32_bf16 v[116:119], v[36:39], v[52:55], 0
    ds_read_b64 v[70:71], v1 offset:2376
    s_waitcnt lgkmcnt(10)
    v_mfma_f32_16x16x32_bf16 v[96:99], v[32:35], v[48:51], 0
    ds_read_b128 v[84:87], v2 offset:2016
    v_mfma_f32_16x16x32_bf16 v[112:115], v[36:39], v[48:51], 0
    ds_read_b128 v[80:83], v2 offset:480
    s_waitcnt lgkmcnt(10)
    v_mfma_f32_16x16x32_bf16 v[108:111], v[40:43], v[52:55], v[108:111]
    ds_read_b64 v[72:73], v1 offset:352
    s_waitcnt lgkmcnt(9)
    v_mfma_f32_16x16x32_bf16 v[124:127], v[44:47], v[52:55], v[124:127]
    ds_read_b64 v[74:75], v1 offset:360
    v_mfma_f32_16x16x32_bf16 v[104:107], v[40:43], v[48:51], v[104:107]
    ds_read_b64 v[76:77], v1 offset:320
    v_mfma_f32_16x16x32_bf16 v[120:123], v[44:47], v[48:51], v[120:123]
    ds_read_b64 v[78:79], v1 offset:328
    s_waitcnt lgkmcnt(10)
    s_waitcnt lgkmcnt(9)
    v_mfma_f32_16x16x32_bf16 v[104:107], v[64:67], v[88:91], v[104:107]
    ds_read_b64 v[32:33], v1 offset:2336
    s_waitcnt lgkmcnt(9)
    v_mfma_f32_16x16x32_bf16 v[108:111], v[64:67], v[92:95], v[108:111]
    ds_read_b64 v[34:35], v1 offset:2344
    s_waitcnt lgkmcnt(8)
    v_mfma_f32_16x16x32_bf16 v[120:123], v[68:71], v[88:91], v[120:123]
    ds_read_b128 v[56:59], v2 offset:3456
    v_mfma_f32_16x16x32_bf16 v[124:127], v[68:71], v[92:95], v[124:127]
    ds_read_b128 v[60:63], v2 offset:4992
    s_waitcnt lgkmcnt(9)
    v_mfma_f32_16x16x32_bf16 v[100:103], v[64:67], v[84:87], v[100:103]
    ds_read_b64 v[36:37], v1 offset:2304
    v_mfma_f32_16x16x32_bf16 v[116:119], v[68:71], v[84:87], v[116:119]
    ds_read_b64 v[38:39], v1 offset:2312
    s_waitcnt lgkmcnt(10)
    v_mfma_f32_16x16x32_bf16 v[96:99], v[64:67], v[80:83], v[96:99]
    ds_read_b128 v[52:55], v2 offset:1920
    v_mfma_f32_16x16x32_bf16 v[112:115], v[68:71], v[80:83], v[112:115]
    ds_read_b128 v[48:51], v2 offset:384
    s_waitcnt lgkmcnt(10)
    v_mfma_f32_16x16x32_bf16 v[108:111], v[72:75], v[84:87], v[108:111]
    ds_read_b64 v[40:41], v1 offset:288
    s_waitcnt lgkmcnt(9)
    v_mfma_f32_16x16x32_bf16 v[124:127], v[76:79], v[84:87], v[124:127]
    ds_read_b64 v[42:43], v1 offset:296
    v_mfma_f32_16x16x32_bf16 v[104:107], v[72:75], v[80:83], v[104:107]
    ds_read_b64 v[44:45], v1 offset:256
    v_mfma_f32_16x16x32_bf16 v[120:123], v[76:79], v[80:83], v[120:123]
    ds_read_b64 v[46:47], v1 offset:264
    s_waitcnt lgkmcnt(10)
    s_waitcnt lgkmcnt(9)
    v_mfma_f32_16x16x32_bf16 v[104:107], v[32:35], v[56:59], v[104:107]
    ds_read_b64 v[64:65], v1 offset:2272
    s_waitcnt lgkmcnt(9)
    v_mfma_f32_16x16x32_bf16 v[108:111], v[32:35], v[60:63], v[108:111]
    ds_read_b64 v[66:67], v1 offset:2280
    s_waitcnt lgkmcnt(8)
    v_mfma_f32_16x16x32_bf16 v[120:123], v[36:39], v[56:59], v[120:123]
    ds_read_b128 v[88:91], v2 offset:3360
    v_mfma_f32_16x16x32_bf16 v[124:127], v[36:39], v[60:63], v[124:127]
    ds_read_b128 v[92:95], v2 offset:4896
    s_waitcnt lgkmcnt(9)
    v_mfma_f32_16x16x32_bf16 v[100:103], v[32:35], v[52:55], v[100:103]
    ds_read_b64 v[68:69], v1 offset:2240
    v_mfma_f32_16x16x32_bf16 v[116:119], v[36:39], v[52:55], v[116:119]
    ds_read_b64 v[70:71], v1 offset:2248
    s_waitcnt lgkmcnt(10)
    v_mfma_f32_16x16x32_bf16 v[96:99], v[32:35], v[48:51], v[96:99]
    ds_read_b128 v[84:87], v2 offset:1824
    v_mfma_f32_16x16x32_bf16 v[112:115], v[36:39], v[48:51], v[112:115]
    ds_read_b128 v[80:83], v2 offset:288
    s_waitcnt lgkmcnt(10)
    v_mfma_f32_16x16x32_bf16 v[108:111], v[40:43], v[52:55], v[108:111]
    ds_read_b64 v[72:73], v1 offset:224
    s_waitcnt lgkmcnt(9)
    v_mfma_f32_16x16x32_bf16 v[124:127], v[44:47], v[52:55], v[124:127]
    ds_read_b64 v[74:75], v1 offset:232
    v_mfma_f32_16x16x32_bf16 v[104:107], v[40:43], v[48:51], v[104:107]
    ds_read_b64 v[76:77], v1 offset:192
    v_mfma_f32_16x16x32_bf16 v[120:123], v[44:47], v[48:51], v[120:123]
    ds_read_b64 v[78:79], v1 offset:200
    s_waitcnt lgkmcnt(10)
    s_waitcnt lgkmcnt(9)
    v_mfma_f32_16x16x32_bf16 v[104:107], v[64:67], v[88:91], v[104:107]
    ds_read_b64 v[32:33], v1 offset:2208
    s_waitcnt lgkmcnt(9)
    v_mfma_f32_16x16x32_bf16 v[108:111], v[64:67], v[92:95], v[108:111]
    ds_read_b64 v[34:35], v1 offset:2216
    s_waitcnt lgkmcnt(8)
    v_mfma_f32_16x16x32_bf16 v[120:123], v[68:71], v[88:91], v[120:123]
    ds_read_b128 v[56:59], v2 offset:3264
    v_mfma_f32_16x16x32_bf16 v[124:127], v[68:71], v[92:95], v[124:127]
    ds_read_b128 v[60:63], v2 offset:4800
    s_waitcnt lgkmcnt(9)
    v_mfma_f32_16x16x32_bf16 v[100:103], v[64:67], v[84:87], v[100:103]
    ds_read_b64 v[36:37], v1 offset:2176
    v_mfma_f32_16x16x32_bf16 v[116:119], v[68:71], v[84:87], v[116:119]
    ds_read_b64 v[38:39], v1 offset:2184
    s_waitcnt lgkmcnt(10)
    v_mfma_f32_16x16x32_bf16 v[96:99], v[64:67], v[80:83], v[96:99]
    ds_read_b128 v[52:55], v2 offset:1728
    v_mfma_f32_16x16x32_bf16 v[112:115], v[68:71], v[80:83], v[112:115]
    ds_read_b128 v[48:51], v2 offset:192
    s_waitcnt lgkmcnt(10)
    v_mfma_f32_16x16x32_bf16 v[108:111], v[72:75], v[84:87], v[108:111]
    ds_read_b64 v[40:41], v1 offset:160
    s_waitcnt lgkmcnt(9)
    v_mfma_f32_16x16x32_bf16 v[124:127], v[76:79], v[84:87], v[124:127]
    ds_read_b64 v[42:43], v1 offset:168
    v_mfma_f32_16x16x32_bf16 v[104:107], v[72:75], v[80:83], v[104:107]
    ds_read_b64 v[44:45], v1 offset:128
    v_mfma_f32_16x16x32_bf16 v[120:123], v[76:79], v[80:83], v[120:123]
    ds_read_b64 v[46:47], v1 offset:136
    s_waitcnt lgkmcnt(10)
    s_waitcnt lgkmcnt(9)
    v_mfma_f32_16x16x32_bf16 v[104:107], v[32:35], v[56:59], v[104:107]
    ds_read_b64 v[64:65], v1 offset:2144
    s_waitcnt lgkmcnt(9)
    v_mfma_f32_16x16x32_bf16 v[108:111], v[32:35], v[60:63], v[108:111]
    ds_read_b64 v[66:67], v1 offset:2152
    s_waitcnt lgkmcnt(8)
    v_mfma_f32_16x16x32_bf16 v[120:123], v[36:39], v[56:59], v[120:123]
    ds_read_b128 v[88:91], v2 offset:3168
    v_mfma_f32_16x16x32_bf16 v[124:127], v[36:39], v[60:63], v[124:127]
    ds_read_b128 v[92:95], v2 offset:4704
    s_waitcnt lgkmcnt(9)
    v_mfma_f32_16x16x32_bf16 v[100:103], v[32:35], v[52:55], v[100:103]
    ds_read_b64 v[68:69], v1 offset:2112
    v_mfma_f32_16x16x32_bf16 v[116:119], v[36:39], v[52:55], v[116:119]
    ds_read_b64 v[70:71], v1 offset:2120
    s_waitcnt lgkmcnt(10)
    v_mfma_f32_16x16x32_bf16 v[96:99], v[32:35], v[48:51], v[96:99]
    ds_read_b128 v[84:87], v2 offset:1632
    v_mfma_f32_16x16x32_bf16 v[112:115], v[36:39], v[48:51], v[112:115]
    ds_read_b128 v[80:83], v2 offset:96
    s_waitcnt lgkmcnt(10)
    v_mfma_f32_16x16x32_bf16 v[108:111], v[40:43], v[52:55], v[108:111]
    ds_read_b64 v[72:73], v1 offset:96
    s_waitcnt lgkmcnt(9)
    v_mfma_f32_16x16x32_bf16 v[124:127], v[44:47], v[52:55], v[124:127]
    ds_read_b64 v[74:75], v1 offset:104
    v_mfma_f32_16x16x32_bf16 v[104:107], v[40:43], v[48:51], v[104:107]
    ds_read_b64 v[76:77], v1 offset:64
    v_mfma_f32_16x16x32_bf16 v[120:123], v[44:47], v[48:51], v[120:123]
    ds_read_b64 v[78:79], v1 offset:72
    s_waitcnt lgkmcnt(10)
    s_waitcnt lgkmcnt(9)
    v_mfma_f32_16x16x32_bf16 v[104:107], v[64:67], v[88:91], v[104:107]
    ds_read_b64 v[32:33], v1 offset:2080
    s_waitcnt lgkmcnt(9)
    v_mfma_f32_16x16x32_bf16 v[108:111], v[64:67], v[92:95], v[108:111]
    ds_read_b64 v[34:35], v1 offset:2088
    s_waitcnt lgkmcnt(8)
    v_mfma_f32_16x16x32_bf16 v[120:123], v[68:71], v[88:91], v[120:123]
    ds_read_b128 v[56:59], v2 offset:3072
    v_mfma_f32_16x16x32_bf16 v[124:127], v[68:71], v[92:95], v[124:127]
    ds_read_b128 v[60:63], v2 offset:4608
    s_waitcnt lgkmcnt(9)
    v_mfma_f32_16x16x32_bf16 v[100:103], v[64:67], v[84:87], v[100:103]
    ds_read_b64 v[36:37], v1 offset:2048
    v_mfma_f32_16x16x32_bf16 v[116:119], v[68:71], v[84:87], v[116:119]
    ds_read_b64 v[38:39], v1 offset:2056
    s_waitcnt lgkmcnt(10)
    v_mfma_f32_16x16x32_bf16 v[96:99], v[64:67], v[80:83], v[96:99]
    ds_read_b128 v[52:55], v2 offset:1536
    v_mfma_f32_16x16x32_bf16 v[112:115], v[68:71], v[80:83], v[112:115]
    ds_read_b128 v[48:51], v2 offset:0
    s_waitcnt lgkmcnt(10)
    v_mfma_f32_16x16x32_bf16 v[108:111], v[72:75], v[84:87], v[108:111]
    ds_read_b64 v[40:41], v1 offset:32
    s_waitcnt lgkmcnt(9)
    v_mfma_f32_16x16x32_bf16 v[124:127], v[76:79], v[84:87], v[124:127]
    ds_read_b64 v[42:43], v1 offset:40
    v_mfma_f32_16x16x32_bf16 v[104:107], v[72:75], v[80:83], v[104:107]
    ds_read_b64 v[44:45], v1 offset:0
    v_mfma_f32_16x16x32_bf16 v[120:123], v[76:79], v[80:83], v[120:123]
    ds_read_b64 v[46:47], v1 offset:8
    s_waitcnt lgkmcnt(10)
    s_waitcnt lgkmcnt(9)
    v_mfma_f32_16x16x32_bf16 v[104:107], v[32:35], v[56:59], v[104:107]
    s_waitcnt lgkmcnt(8)
    v_mfma_f32_16x16x32_bf16 v[108:111], v[32:35], v[60:63], v[108:111]
    s_waitcnt lgkmcnt(6)
    v_mfma_f32_16x16x32_bf16 v[120:123], v[36:39], v[56:59], v[120:123]
    v_mfma_f32_16x16x32_bf16 v[124:127], v[36:39], v[60:63], v[124:127]
    s_waitcnt lgkmcnt(5)
    v_mfma_f32_16x16x32_bf16 v[100:103], v[32:35], v[52:55], v[100:103]
    v_mfma_f32_16x16x32_bf16 v[116:119], v[36:39], v[52:55], v[116:119]
    s_waitcnt lgkmcnt(4)
    v_mfma_f32_16x16x32_bf16 v[96:99], v[32:35], v[48:51], v[96:99]
    v_mfma_f32_16x16x32_bf16 v[112:115], v[36:39], v[48:51], v[112:115]
    s_waitcnt lgkmcnt(2)
    v_mfma_f32_16x16x32_bf16 v[108:111], v[40:43], v[52:55], v[108:111]
    s_waitcnt lgkmcnt(0)
    v_mfma_f32_16x16x32_bf16 v[124:127], v[44:47], v[52:55], v[124:127]
    v_mfma_f32_16x16x32_bf16 v[104:107], v[40:43], v[48:51], v[104:107]
    v_mfma_f32_16x16x32_bf16 v[120:123], v[44:47], v[48:51], v[120:123]
    s_branch L_cv16_done
L_cv16_w2:
    s_cmp_lg_u32 s54, 2
    s_cbranch_scc1 L_cv16_w3
    ds_read_b64 v[32:33], v1 offset:2528
    ds_read_b64 v[34:35], v1 offset:2536
    ds_read_b128 v[56:59], v2 offset:3744
    ds_read_b128 v[60:63], v2 offset:5280
    ds_read_b64 v[36:37], v1 offset:2496
    ds_read_b64 v[38:39], v1 offset:2504
    ds_read_b128 v[52:55], v2 offset:2208
    ds_read_b128 v[48:51], v2 offset:672
    ds_read_b64 v[40:41], v1 offset:480
    ds_read_b64 v[42:43], v1 offset:488
    ds_read_b64 v[44:45], v1 offset:448
    ds_read_b64 v[46:47], v1 offset:456
    s_waitcnt lgkmcnt(10)
    s_waitcnt lgkmcnt(9)
    v_mfma_f32_16x16x32_bf16 v[104:107], v[32:35], v[56:59], 0
    ds_read_b64 v[64:65], v1 offset:2464
    s_waitcnt lgkmcnt(9)
    v_mfma_f32_16x16x32_bf16 v[108:111], v[32:35], v[60:63], 0
    ds_read_b64 v[66:67], v1 offset:2472
    s_waitcnt lgkmcnt(8)
    v_mfma_f32_16x16x32_bf16 v[120:123], v[36:39], v[56:59], 0
    ds_read_b128 v[88:91], v2 offset:3648
    v_mfma_f32_16x16x32_bf16 v[124:127], v[36:39], v[60:63], 0
    ds_read_b128 v[92:95], v2 offset:5184
    s_waitcnt lgkmcnt(9)
    v_mfma_f32_16x16x32_bf16 v[100:103], v[32:35], v[52:55], 0
    ds_read_b64 v[68:69], v1 offset:2432
    v_mfma_f32_16x16x32_bf16 v[116:119], v[36:39], v[52:55], 0
    ds_read_b64 v[70:71], v1 offset:2440
    s_waitcnt lgkmcnt(10)
    v_mfma_f32_16x16x32_bf16 v[96:99], v[32:35], v[48:51], 0
    ds_read_b128 v[84:87], v2 offset:2112
    v_mfma_f32_16x16x32_bf16 v[112:115], v[36:39], v[48:51], 0
    ds_read_b128 v[80:83], v2 offset:576
    s_waitcnt lgkmcnt(10)
    v_mfma_f32_16x16x32_bf16 v[108:111], v[40:43], v[52:55], v[108:111]
    ds_read_b64 v[72:73], v1 offset:416
    s_waitcnt lgkmcnt(9)
    v_mfma_f32_16x16x32_bf16 v[124:127], v[44:47], v[52:55], v[124:127]
    ds_read_b64 v[74:75], v1 offset:424
    v_mfma_f32_16x16x32_bf16 v[104:107], v[40:43], v[48:51], v[104:107]
    ds_read_b64 v[76:77], v1 offset:384
    v_mfma_f32_16x16x32_bf16 v[120:123], v[44:47], v[48:51], v[120:123]
    ds_read_b64 v[78:79], v1 offset:392
    s_waitcnt lgkmcnt(10)
    s_waitcnt lgkmcnt(9)
    v_mfma_f32_16x16x32_bf16 v[104:107], v[64:67], v[88:91], v[104:107]
    s_waitcnt lgkmcnt(8)
    v_mfma_f32_16x16x32_bf16 v[108:111], v[64:67], v[92:95], v[108:111]
    ds_read_b64 v[32:33], v1 offset:2400
    s_waitcnt lgkmcnt(7)
    v_mfma_f32_16x16x32_bf16 v[120:123], v[68:71], v[88:91], v[120:123]
    ds_read_b64 v[34:35], v1 offset:2408
    v_mfma_f32_16x16x32_bf16 v[124:127], v[68:71], v[92:95], v[124:127]
    ds_read_b128 v[56:59], v2 offset:3552
    s_waitcnt lgkmcnt(8)
    v_mfma_f32_16x16x32_bf16 v[100:103], v[64:67], v[84:87], v[100:103]
    ds_read_b128 v[60:63], v2 offset:5088
    v_mfma_f32_16x16x32_bf16 v[116:119], v[68:71], v[84:87], v[116:119]
    ds_read_b64 v[36:37], v1 offset:2368
    s_waitcnt lgkmcnt(9)
    v_mfma_f32_16x16x32_bf16 v[96:99], v[64:67], v[80:83], v[96:99]
    ds_read_b64 v[38:39], v1 offset:2376
    v_mfma_f32_16x16x32_bf16 v[112:115], v[68:71], v[80:83], v[112:115]
    ds_read_b128 v[52:55], v2 offset:2016
    s_waitcnt lgkmcnt(9)
    v_mfma_f32_16x16x32_bf16 v[108:111], v[72:75], v[84:87], v[108:111]
    ds_read_b64 v[40:41], v1 offset:352
    s_waitcnt lgkmcnt(8)
    v_mfma_f32_16x16x32_bf16 v[124:127], v[76:79], v[84:87], v[124:127]
    ds_read_b64 v[42:43], v1 offset:360
    v_mfma_f32_16x16x32_bf16 v[104:107], v[72:75], v[80:83], v[104:107]
    ds_read_b64 v[44:45], v1 offset:320
    v_mfma_f32_16x16x32_bf16 v[120:123], v[76:79], v[80:83], v[120:123]
    ds_read_b64 v[46:47], v1 offset:328
    s_waitcnt lgkmcnt(9)
    s_waitcnt lgkmcnt(8)
    v_mfma_f32_16x16x32_bf16 v[104:107], v[32:35], v[56:59], v[104:107]
    ds_read_b64 v[64:65], v1 offset:2336
    s_waitcnt lgkmcnt(8)
    v_mfma_f32_16x16x32_bf16 v[108:111], v[32:35], v[60:63], v[108:111]
    ds_read_b64 v[66:67], v1 offset:2344
    s_waitcnt lgkmcnt(7)
    v_mfma_f32_16x16x32_bf16 v[120:123], v[36:39], v[56:59], v[120:123]
    ds_read_b128 v[88:91], v2 offset:3456
    ds_read_b128 v[92:95], v2 offset:4992
    v_mfma_f32_16x16x32_bf16 v[124:127], v[36:39], v[60:63], v[124:127]
    ds_read_b64 v[68:69], v1 offset:2304
    s_waitcnt lgkmcnt(9)
    v_mfma_f32_16x16x32_bf16 v[100:103], v[32:35], v[52:55], v[100:103]
    ds_read_b64 v[70:71], v1 offset:2312
    v_mfma_f32_16x16x32_bf16 v[116:119], v[36:39], v[52:55], v[116:119]
    ds_read_b128 v[84:87], v2 offset:1920
    ds_read_b64 v[72:73], v1 offset:288
    s_waitcnt lgkmcnt(10)
    v_mfma_f32_16x16x32_bf16 v[108:111], v[40:43], v[52:55], v[108:111]
    ds_read_b64 v[74:75], v1 offset:296
    s_waitcnt lgkmcnt(9)
    v_mfma_f32_16x16x32_bf16 v[124:127], v[44:47], v[52:55], v[124:127]
    ds_read_b64 v[76:77], v1 offset:256
    ds_read_b64 v[78:79], v1 offset:264
    s_waitcnt lgkmcnt(9)
    s_waitcnt lgkmcnt(8)
    v_mfma_f32_16x16x32_bf16 v[104:107], v[64:67], v[88:91], v[104:107]
    ds_read_b64 v[32:33], v1 offset:2272
    s_waitcnt lgkmcnt(8)
    v_mfma_f32_16x16x32_bf16 v[108:111], v[64:67], v[92:95], v[108:111]
    ds_read_b64 v[34:35], v1 offset:2280
    s_waitcnt lgkmcnt(7)
    v_mfma_f32_16x16x32_bf16 v[120:123], v[68:71], v[88:91], v[120:123]
    ds_read_b128 v[56:59], v2 offset:3360
    ds_read_b128 v[60:63], v2 offset:4896
    v_mfma_f32_16x16x32_bf16 v[124:127], v[68:71], v[92:95], v[124:127]
    ds_read_b64 v[36:37], v1 offset:2240
    s_waitcnt lgkmcnt(9)
    v_mfma_f32_16x16x32_bf16 v[100:103], v[64:67], v[84:87], v[100:103]
    ds_read_b64 v[38:39], v1 offset:2248
    v_mfma_f32_16x16x32_bf16 v[116:119], v[68:71], v[84:87], v[116:119]
    ds_read_b128 v[52:55], v2 offset:1824
    ds_read_b64 v[40:41], v1 offset:224
    s_waitcnt lgkmcnt(10)
    v_mfma_f32_16x16x32_bf16 v[108:111], v[72:75], v[84:87], v[108:111]
    ds_read_b64 v[42:43], v1 offset:232
    s_waitcnt lgkmcnt(9)
    v_mfma_f32_16x16x32_bf16 v[124:127], v[76:79], v[84:87], v[124:127]
    ds_read_b64 v[44:45], v1 offset:192
    ds_read_b64 v[46:47], v1 offset:200
    s_waitcnt lgkmcnt(9)
    s_waitcnt lgkmcnt(8)
    v_mfma_f32_16x16x32_bf16 v[104:107], v[32:35], v[56:59], v[104:107]
    ds_read_b64 v[64:65], v1 offset:2208
    s_waitcnt lgkmcnt(8)
    v_mfma_f32_16x16x32_bf16 v[108:111], v[32:35], v[60:63], v[108:111]
    ds_read_b64 v[66:67], v1 offset:2216
    s_waitcnt lgkmcnt(7)
    v_mfma_f32_16x16x32_bf16 v[120:123], v[36:39], v[56:59], v[120:123]
    ds_read_b128 v[88:91], v2 offset:3264
    ds_read_b128 v[92:95], v2 offset:4800
    v_mfma_f32_16x16x32_bf16 v[124:127], v[36:39], v[60:63], v[124:127]
    ds_read_b64 v[68:69], v1 offset:2176
    s_waitcnt lgkmcnt(9)
    v_mfma_f32_16x16x32_bf16 v[100:103], v[32:35], v[52:55], v[100:103]
    ds_read_b64 v[70:71], v1 offset:2184
    v_mfma_f32_16x16x32_bf16 v[116:119], v[36:39], v[52:55], v[116:119]
    ds_read_b128 v[84:87], v2 offset:1728
    ds_read_b64 v[72:73], v1 offset:160
    s_waitcnt lgkmcnt(10)
    v_mfma_f32_16x16x32_bf16 v[108:111], v[40:43], v[52:55], v[108:111]
    ds_read_b64 v[74:75], v1 offset:168
    s_waitcnt lgkmcnt(9)
    v_mfma_f32_16x16x32_bf16 v[124:127], v[44:47], v[52:55], v[124:127]
    ds_read_b64 v[76:77], v1 offset:128
    ds_read_b64 v[78:79], v1 offset:136
    s_waitcnt lgkmcnt(9)
    s_waitcnt lgkmcnt(8)
    v_mfma_f32_16x16x32_bf16 v[104:107], v[64:67], v[88:91], v[104:107]
    ds_read_b64 v[32:33], v1 offset:2144
    s_waitcnt lgkmcnt(8)
    v_mfma_f32_16x16x32_bf16 v[108:111], v[64:67], v[92:95], v[108:111]
    ds_read_b64 v[34:35], v1 offset:2152
    s_waitcnt lgkmcnt(7)
    v_mfma_f32_16x16x32_bf16 v[120:123], v[68:71], v[88:91], v[120:123]
    ds_read_b128 v[56:59], v2 offset:3168
    ds_read_b128 v[60:63], v2 offset:4704
    v_mfma_f32_16x16x32_bf16 v[124:127], v[68:71], v[92:95], v[124:127]
    ds_read_b64 v[36:37], v1 offset:2112
    s_waitcnt lgkmcnt(9)
    v_mfma_f32_16x16x32_bf16 v[100:103], v[64:67], v[84:87], v[100:103]
    ds_read_b64 v[38:39], v1 offset:2120
    v_mfma_f32_16x16x32_bf16 v[116:119], v[68:71], v[84:87], v[116:119]
    ds_read_b128 v[52:55], v2 offset:1632
    ds_read_b64 v[40:41], v1 offset:96
    s_waitcnt lgkmcnt(10)
    v_mfma_f32_16x16x32_bf16 v[108:111], v[72:75], v[84:87], v[108:111]
    ds_read_b64 v[42:43], v1 offset:104
    s_waitcnt lgkmcnt(9)
    v_mfma_f32_16x16x32_bf16 v[124:127], v[76:79], v[84:87], v[124:127]
    ds_read_b64 v[44:45], v1 offset:64
    ds_read_b64 v[46:47], v1 offset:72
    s_waitcnt lgkmcnt(9)
    s_waitcnt lgkmcnt(8)
    v_mfma_f32_16x16x32_bf16 v[104:107], v[32:35], v[56:59], v[104:107]
    ds_read_b64 v[64:65], v1 offset:2080
    s_waitcnt lgkmcnt(8)
    v_mfma_f32_16x16x32_bf16 v[108:111], v[32:35], v[60:63], v[108:111]
    ds_read_b64 v[66:67], v1 offset:2088
    s_waitcnt lgkmcnt(7)
    v_mfma_f32_16x16x32_bf16 v[120:123], v[36:39], v[56:59], v[120:123]
    ds_read_b128 v[88:91], v2 offset:3072
    ds_read_b128 v[92:95], v2 offset:4608
    v_mfma_f32_16x16x32_bf16 v[124:127], v[36:39], v[60:63], v[124:127]
    ds_read_b64 v[68:69], v1 offset:2048
    s_waitcnt lgkmcnt(9)
    v_mfma_f32_16x16x32_bf16 v[100:103], v[32:35], v[52:55], v[100:103]
    ds_read_b64 v[70:71], v1 offset:2056
    v_mfma_f32_16x16x32_bf16 v[116:119], v[36:39], v[52:55], v[116:119]
    ds_read_b128 v[84:87], v2 offset:1536
    ds_read_b64 v[72:73], v1 offset:32
    s_waitcnt lgkmcnt(10)
    v_mfma_f32_16x16x32_bf16 v[108:111], v[40:43], v[52:55], v[108:111]
    ds_read_b64 v[74:75], v1 offset:40
    s_waitcnt lgkmcnt(9)
    v_mfma_f32_16x16x32_bf16 v[124:127], v[44:47], v[52:55], v[124:127]
    ds_read_b64 v[76:77], v1 offset:0
    ds_read_b64 v[78:79], v1 offset:8
    s_waitcnt lgkmcnt(9)
    s_waitcnt lgkmcnt(8)
    v_mfma_f32_16x16x32_bf16 v[104:107], v[64:67], v[88:91], v[104:107]
    s_waitcnt lgkmcnt(7)
    v_mfma_f32_16x16x32_bf16 v[108:111], v[64:67], v[92:95], v[108:111]
    s_waitcnt lgkmcnt(5)
    v_mfma_f32_16x16x32_bf16 v[120:123], v[68:71], v[88:91], v[120:123]
    v_mfma_f32_16x16x32_bf16 v[124:127], v[68:71], v[92:95], v[124:127]
    s_waitcnt lgkmcnt(4)
    v_mfma_f32_16x16x32_bf16 v[100:103], v[64:67], v[84:87], v[100:103]
    v_mfma_f32_16x16x32_bf16 v[116:119], v[68:71], v[84:87], v[116:119]
    s_waitcnt lgkmcnt(2)
    v_mfma_f32_16x16x32_bf16 v[108:111], v[72:75], v[84:87], v[108:111]
    s_waitcnt lgkmcnt(0)
    v_mfma_f32_16x16x32_bf16 v[124:127], v[76:79], v[84:87], v[124:127]
    s_branch L_cv16_done
L_cv16_w3:
    ds_read_b64 v[32:33], v1 offset:2656
    ds_read_b64 v[34:35], v1 offset:2664
    ds_read_b128 v[56:59], v2 offset:3936
    ds_read_b128 v[60:63], v2 offset:5472
    ds_read_b64 v[36:37], v1 offset:2624
    ds_read_b64 v[38:39], v1 offset:2632
    ds_read_b128 v[52:55], v2 offset:2400
    ds_read_b64 v[40:41], v1 offset:608
    ds_read_b64 v[42:43], v1 offset:616
    ds_read_b64 v[44:45], v1 offset:576
    ds_read_b64 v[46:47], v1 offset:584
    s_waitcnt lgkmcnt(9)
    s_waitcnt lgkmcnt(8)
    v_mfma_f32_16x16x32_bf16 v[104:107], v[32:35], v[56:59], 0
    ds_read_b64 v[64:65], v1 offset:2592
    s_waitcnt lgkmcnt(8)
    v_mfma_f32_16x16x32_bf16 v[108:111], v[32:35], v[60:63], 0
    ds_read_b64 v[66:67], v1 offset:2600
    s_waitcnt lgkmcnt(7)
    v_mfma_f32_16x16x32_bf16 v[120:123], v[36:39], v[56:59], 0
    ds_read_b128 v[88:91], v2 offset:3840
    ds_read_b128 v[92:95], v2 offset:5376
    v_mfma_f32_16x16x32_bf16 v[124:127], v[36:39], v[60:63], 0
    ds_read_b64 v[68:69], v1 offset:2560
    s_waitcnt lgkmcnt(9)
    v_mfma_f32_16x16x32_bf16 v[100:103], v[32:35], v[52:55], 0
    ds_read_b64 v[70:71], v1 offset:2568
    v_mfma_f32_16x16x32_bf16 v[116:119], v[36:39], v[52:55], 0
    ds_read_b128 v[84:87], v2 offset:2304
    ds_read_b64 v[72:73], v1 offset:544
    s_waitcnt lgkmcnt(10)
    v_mfma_f32_16x16x32_bf16 v[108:111], v[40:43], v[52:55], v[108:111]
    ds_read_b64 v[74:75], v1 offset:552
    s_waitcnt lgkmcnt(9)
    v_mfma_f32_16x16x32_bf16 v[124:127], v[44:47], v[52:55], v[124:127]
    ds_read_b64 v[76:77], v1 offset:512
    ds_read_b64 v[78:79], v1 offset:520
    s_waitcnt lgkmcnt(9)
    s_waitcnt lgkmcnt(8)
    v_mfma_f32_16x16x32_bf16 v[104:107], v[64:67], v[88:91], v[104:107]
    ds_read_b64 v[32:33], v1 offset:2528
    s_waitcnt lgkmcnt(8)
    v_mfma_f32_16x16x32_bf16 v[108:111], v[64:67], v[92:95], v[108:111]
    ds_read_b64 v[34:35], v1 offset:2536
    s_waitcnt lgkmcnt(7)
    v_mfma_f32_16x16x32_bf16 v[120:123], v[68:71], v[88:91], v[120:123]
    ds_read_b128 v[56:59], v2 offset:3744
    ds_read_b128 v[60:63], v2 offset:5280
    v_mfma_f32_16x16x32_bf16 v[124:127], v[68:71], v[92:95], v[124:127]
    ds_read_b64 v[36:37], v1 offset:2496
    s_waitcnt lgkmcnt(9)
    v_mfma_f32_16x16x32_bf16 v[100:103], v[64:67], v[84:87], v[100:103]
    ds_read_b64 v[38:39], v1 offset:2504
    v_mfma_f32_16x16x32_bf16 v[116:119], v[68:71], v[84:87], v[116:119]
    ds_read_b128 v[52:55], v2 offset:2208
    ds_read_b64 v[40:41], v1 offset:480
    s_waitcnt lgkmcnt(10)
    v_mfma_f32_16x16x32_bf16 v[108:111], v[72:75], v[84:87], v[108:111]
    ds_read_b64 v[42:43], v1 offset:488
    s_waitcnt lgkmcnt(9)
    v_mfma_f32_16x16x32_bf16 v[124:127], v[76:79], v[84:87], v[124:127]
    ds_read_b64 v[44:45], v1 offset:448
    ds_read_b64 v[46:47], v1 offset:456
    s_waitcnt lgkmcnt(9)
    s_waitcnt lgkmcnt(8)
    v_mfma_f32_16x16x32_bf16 v[104:107], v[32:35], v[56:59], v[104:107]
    ds_read_b64 v[64:65], v1 offset:2464
    s_waitcnt lgkmcnt(8)
    v_mfma_f32_16x16x32_bf16 v[108:111], v[32:35], v[60:63], v[108:111]
    ds_read_b64 v[66:67], v1 offset:2472
    s_waitcnt lgkmcnt(7)
    v_mfma_f32_16x16x32_bf16 v[120:123], v[36:39], v[56:59], v[120:123]
    ds_read_b128 v[88:91], v2 offset:3648
    ds_read_b128 v[92:95], v2 offset:5184
    v_mfma_f32_16x16x32_bf16 v[124:127], v[36:39], v[60:63], v[124:127]
    ds_read_b64 v[68:69], v1 offset:2432
    s_waitcnt lgkmcnt(9)
    v_mfma_f32_16x16x32_bf16 v[100:103], v[32:35], v[52:55], v[100:103]
    ds_read_b64 v[70:71], v1 offset:2440
    v_mfma_f32_16x16x32_bf16 v[116:119], v[36:39], v[52:55], v[116:119]
    ds_read_b128 v[84:87], v2 offset:2112
    ds_read_b64 v[72:73], v1 offset:416
    s_waitcnt lgkmcnt(10)
    v_mfma_f32_16x16x32_bf16 v[108:111], v[40:43], v[52:55], v[108:111]
    ds_read_b64 v[74:75], v1 offset:424
    s_waitcnt lgkmcnt(9)
    v_mfma_f32_16x16x32_bf16 v[124:127], v[44:47], v[52:55], v[124:127]
    ds_read_b64 v[76:77], v1 offset:384
    ds_read_b64 v[78:79], v1 offset:392
    s_waitcnt lgkmcnt(9)
    s_waitcnt lgkmcnt(8)
    v_mfma_f32_16x16x32_bf16 v[104:107], v[64:67], v[88:91], v[104:107]
    ds_read_b64 v[32:33], v1 offset:2400
    s_waitcnt lgkmcnt(8)
    v_mfma_f32_16x16x32_bf16 v[108:111], v[64:67], v[92:95], v[108:111]
    ds_read_b64 v[34:35], v1 offset:2408
    s_waitcnt lgkmcnt(7)
    v_mfma_f32_16x16x32_bf16 v[120:123], v[68:71], v[88:91], v[120:123]
    ds_read_b128 v[56:59], v2 offset:3552
    ds_read_b128 v[60:63], v2 offset:5088
    v_mfma_f32_16x16x32_bf16 v[124:127], v[68:71], v[92:95], v[124:127]
    ds_read_b64 v[36:37], v1 offset:2368
    s_waitcnt lgkmcnt(9)
    v_mfma_f32_16x16x32_bf16 v[100:103], v[64:67], v[84:87], v[100:103]
    ds_read_b64 v[38:39], v1 offset:2376
    v_mfma_f32_16x16x32_bf16 v[116:119], v[68:71], v[84:87], v[116:119]
    ds_read_b128 v[52:55], v2 offset:2016
    ds_read_b64 v[40:41], v1 offset:352
    s_waitcnt lgkmcnt(10)
    v_mfma_f32_16x16x32_bf16 v[108:111], v[72:75], v[84:87], v[108:111]
    ds_read_b64 v[42:43], v1 offset:360
    s_waitcnt lgkmcnt(9)
    v_mfma_f32_16x16x32_bf16 v[124:127], v[76:79], v[84:87], v[124:127]
    ds_read_b64 v[44:45], v1 offset:320
    ds_read_b64 v[46:47], v1 offset:328
    s_waitcnt lgkmcnt(9)
    s_waitcnt lgkmcnt(8)
    v_mfma_f32_16x16x32_bf16 v[104:107], v[32:35], v[56:59], v[104:107]
    ds_read_b64 v[64:65], v1 offset:2336
    s_waitcnt lgkmcnt(8)
    v_mfma_f32_16x16x32_bf16 v[108:111], v[32:35], v[60:63], v[108:111]
    ds_read_b64 v[66:67], v1 offset:2344
    s_waitcnt lgkmcnt(7)
    v_mfma_f32_16x16x32_bf16 v[120:123], v[36:39], v[56:59], v[120:123]
    ds_read_b128 v[88:91], v2 offset:3456
    ds_read_b128 v[92:95], v2 offset:4992
    v_mfma_f32_16x16x32_bf16 v[124:127], v[36:39], v[60:63], v[124:127]
    ds_read_b64 v[68:69], v1 offset:2304
    s_waitcnt lgkmcnt(9)
    v_mfma_f32_16x16x32_bf16 v[100:103], v[32:35], v[52:55], v[100:103]
    ds_read_b64 v[70:71], v1 offset:2312
    v_mfma_f32_16x16x32_bf16 v[116:119], v[36:39], v[52:55], v[116:119]
    ds_read_b128 v[84:87], v2 offset:1920
    ds_read_b64 v[72:73], v1 offset:288
    s_waitcnt lgkmcnt(10)
    v_mfma_f32_16x16x32_bf16 v[108:111], v[40:43], v[52:55], v[108:111]
    ds_read_b64 v[74:75], v1 offset:296
    s_waitcnt lgkmcnt(9)
    v_mfma_f32_16x16x32_bf16 v[124:127], v[44:47], v[52:55], v[124:127]
    ds_read_b64 v[76:77], v1 offset:256
    ds_read_b64 v[78:79], v1 offset:264
    s_waitcnt lgkmcnt(9)
    s_waitcnt lgkmcnt(8)
    v_mfma_f32_16x16x32_bf16 v[104:107], v[64:67], v[88:91], v[104:107]
    ds_read_b64 v[32:33], v1 offset:2272
    s_waitcnt lgkmcnt(8)
    v_mfma_f32_16x16x32_bf16 v[108:111], v[64:67], v[92:95], v[108:111]
    ds_read_b64 v[34:35], v1 offset:2280
    s_waitcnt lgkmcnt(7)
    v_mfma_f32_16x16x32_bf16 v[120:123], v[68:71], v[88:91], v[120:123]
    ds_read_b128 v[56:59], v2 offset:3360
    ds_read_b128 v[60:63], v2 offset:4896
    v_mfma_f32_16x16x32_bf16 v[124:127], v[68:71], v[92:95], v[124:127]
    ds_read_b64 v[36:37], v1 offset:2240
    s_waitcnt lgkmcnt(9)
    v_mfma_f32_16x16x32_bf16 v[100:103], v[64:67], v[84:87], v[100:103]
    ds_read_b64 v[38:39], v1 offset:2248
    v_mfma_f32_16x16x32_bf16 v[116:119], v[68:71], v[84:87], v[116:119]
    ds_read_b128 v[52:55], v2 offset:1824
    ds_read_b64 v[40:41], v1 offset:224
    s_waitcnt lgkmcnt(10)
    v_mfma_f32_16x16x32_bf16 v[108:111], v[72:75], v[84:87], v[108:111]
    ds_read_b64 v[42:43], v1 offset:232
    s_waitcnt lgkmcnt(9)
    v_mfma_f32_16x16x32_bf16 v[124:127], v[76:79], v[84:87], v[124:127]
    ds_read_b64 v[44:45], v1 offset:192
    ds_read_b64 v[46:47], v1 offset:200
    s_waitcnt lgkmcnt(9)
    s_waitcnt lgkmcnt(8)
    v_mfma_f32_16x16x32_bf16 v[104:107], v[32:35], v[56:59], v[104:107]
    ds_read_b64 v[64:65], v1 offset:2208
    s_waitcnt lgkmcnt(8)
    v_mfma_f32_16x16x32_bf16 v[108:111], v[32:35], v[60:63], v[108:111]
    ds_read_b64 v[66:67], v1 offset:2216
    s_waitcnt lgkmcnt(7)
    v_mfma_f32_16x16x32_bf16 v[120:123], v[36:39], v[56:59], v[120:123]
    ds_read_b128 v[88:91], v2 offset:3264
    ds_read_b128 v[92:95], v2 offset:4800
    v_mfma_f32_16x16x32_bf16 v[124:127], v[36:39], v[60:63], v[124:127]
    ds_read_b64 v[68:69], v1 offset:2176
    s_waitcnt lgkmcnt(9)
    v_mfma_f32_16x16x32_bf16 v[100:103], v[32:35], v[52:55], v[100:103]
    ds_read_b64 v[70:71], v1 offset:2184
    v_mfma_f32_16x16x32_bf16 v[116:119], v[36:39], v[52:55], v[116:119]
    ds_read_b128 v[84:87], v2 offset:1728
    ds_read_b64 v[72:73], v1 offset:160
    s_waitcnt lgkmcnt(10)
    v_mfma_f32_16x16x32_bf16 v[108:111], v[40:43], v[52:55], v[108:111]
    ds_read_b64 v[74:75], v1 offset:168
    s_waitcnt lgkmcnt(9)
    v_mfma_f32_16x16x32_bf16 v[124:127], v[44:47], v[52:55], v[124:127]
    ds_read_b64 v[76:77], v1 offset:128
    ds_read_b64 v[78:79], v1 offset:136
    s_waitcnt lgkmcnt(9)
    s_waitcnt lgkmcnt(8)
    v_mfma_f32_16x16x32_bf16 v[104:107], v[64:67], v[88:91], v[104:107]
    ds_read_b64 v[32:33], v1 offset:2144
    s_waitcnt lgkmcnt(8)
    v_mfma_f32_16x16x32_bf16 v[108:111], v[64:67], v[92:95], v[108:111]
    ds_read_b64 v[34:35], v1 offset:2152
    s_waitcnt lgkmcnt(7)
    v_mfma_f32_16x16x32_bf16 v[120:123], v[68:71], v[88:91], v[120:123]
    ds_read_b128 v[56:59], v2 offset:3168
    ds_read_b128 v[60:63], v2 offset:4704
    v_mfma_f32_16x16x32_bf16 v[124:127], v[68:71], v[92:95], v[124:127]
    ds_read_b64 v[36:37], v1 offset:2112
    s_waitcnt lgkmcnt(9)
    v_mfma_f32_16x16x32_bf16 v[100:103], v[64:67], v[84:87], v[100:103]
    ds_read_b64 v[38:39], v1 offset:2120
    v_mfma_f32_16x16x32_bf16 v[116:119], v[68:71], v[84:87], v[116:119]
    ds_read_b128 v[52:55], v2 offset:1632
    ds_read_b64 v[40:41], v1 offset:96
    s_waitcnt lgkmcnt(10)
    v_mfma_f32_16x16x32_bf16 v[108:111], v[72:75], v[84:87], v[108:111]
    ds_read_b64 v[42:43], v1 offset:104
    s_waitcnt lgkmcnt(9)
    v_mfma_f32_16x16x32_bf16 v[124:127], v[76:79], v[84:87], v[124:127]
    ds_read_b64 v[44:45], v1 offset:64
    ds_read_b64 v[46:47], v1 offset:72
    s_waitcnt lgkmcnt(9)
    s_waitcnt lgkmcnt(8)
    v_mfma_f32_16x16x32_bf16 v[104:107], v[32:35], v[56:59], v[104:107]
    ds_read_b64 v[64:65], v1 offset:2080
    s_waitcnt lgkmcnt(8)
    v_mfma_f32_16x16x32_bf16 v[108:111], v[32:35], v[60:63], v[108:111]
    ds_read_b64 v[66:67], v1 offset:2088
    s_waitcnt lgkmcnt(7)
    v_mfma_f32_16x16x32_bf16 v[120:123], v[36:39], v[56:59], v[120:123]
    ds_read_b128 v[88:91], v2 offset:3072
    ds_read_b128 v[92:95], v2 offset:4608
    v_mfma_f32_16x16x32_bf16 v[124:127], v[36:39], v[60:63], v[124:127]
    ds_read_b64 v[68:69], v1 offset:2048
    s_waitcnt lgkmcnt(9)
    v_mfma_f32_16x16x32_bf16 v[100:103], v[32:35], v[52:55], v[100:103]
    ds_read_b64 v[70:71], v1 offset:2056
    v_mfma_f32_16x16x32_bf16 v[116:119], v[36:39], v[52:55], v[116:119]
    ds_read_b128 v[84:87], v2 offset:1536
    ds_read_b64 v[72:73], v1 offset:32
    s_waitcnt lgkmcnt(10)
    v_mfma_f32_16x16x32_bf16 v[108:111], v[40:43], v[52:55], v[108:111]
    ds_read_b64 v[74:75], v1 offset:40
    s_waitcnt lgkmcnt(9)
    v_mfma_f32_16x16x32_bf16 v[124:127], v[44:47], v[52:55], v[124:127]
    ds_read_b64 v[76:77], v1 offset:0
    ds_read_b64 v[78:79], v1 offset:8
    s_waitcnt lgkmcnt(9)
    s_waitcnt lgkmcnt(8)
    v_mfma_f32_16x16x32_bf16 v[104:107], v[64:67], v[88:91], v[104:107]
    s_waitcnt lgkmcnt(7)
    v_mfma_f32_16x16x32_bf16 v[108:111], v[64:67], v[92:95], v[108:111]
    s_waitcnt lgkmcnt(5)
    v_mfma_f32_16x16x32_bf16 v[120:123], v[68:71], v[88:91], v[120:123]
    v_mfma_f32_16x16x32_bf16 v[124:127], v[68:71], v[92:95], v[124:127]
    s_waitcnt lgkmcnt(4)
    v_mfma_f32_16x16x32_bf16 v[100:103], v[64:67], v[84:87], v[100:103]
    v_mfma_f32_16x16x32_bf16 v[116:119], v[68:71], v[84:87], v[116:119]
    s_waitcnt lgkmcnt(2)
    v_mfma_f32_16x16x32_bf16 v[108:111], v[72:75], v[84:87], v[108:111]
    s_waitcnt lgkmcnt(0)
    v_mfma_f32_16x16x32_bf16 v[124:127], v[76:79], v[84:87], v[124:127]
    v_mov_b32 v96, 0
    v_mov_b32 v97, 0
    v_mov_b32 v98, 0
    v_mov_b32 v99, 0
    v_mov_b32 v112, 0
    v_mov_b32 v113, 0
    v_mov_b32 v114, 0
    v_mov_b32 v115, 0
L_cv16_done:
    s_setprio 1
    s_nop 7
    s_barrier
    ds_write_b128 v4, v[96:99] offset:0
    ds_write_b128 v4, v[100:103] offset:2304
    ds_write_b128 v4, v[104:107] offset:4608
    ds_write_b128 v4, v[108:111] offset:6912
    ds_write_b128 v4, v[112:115] offset:64
    ds_write_b128 v4, v[116:119] offset:2368
    ds_write_b128 v4, v[120:123] offset:4672
    ds_write_b128 v4, v[124:127] offset:6976
    v_mov_b32 v44, v5
    v_mov_b32 v47, v16
    s_waitcnt lgkmcnt(0)
    s_barrier
    ds_read_b128 v[64:67], v44 offset:0
    ds_read_b128 v[68:71], v44 offset:16
    ds_read_b128 v[72:75], v44 offset:9216
    ds_read_b128 v[76:79], v44 offset:9232
    ds_read_b128 v[80:83], v44 offset:18432
    ds_read_b128 v[84:87], v44 offset:18448
    ds_read_b128 v[88:91], v44 offset:27648
    ds_read_b128 v[92:95], v44 offset:27664
    v_lshlrev_b32 v24, 16, v8
    v_and_b32 v25, 0xffff0000, v8
    v_lshlrev_b32 v26, 16, v9
    v_and_b32 v27, 0xffff0000, v9
    v_lshlrev_b32 v28, 16, v10
    v_and_b32 v29, 0xffff0000, v10
    v_lshlrev_b32 v30, 16, v11
    v_and_b32 v31, 0xffff0000, v11
    v_lshlrev_b32 v48, 16, v20
    v_and_b32 v49, 0xffff0000, v20
    v_lshlrev_b32 v50, 16, v21
    v_and_b32 v51, 0xffff0000, v21
    v_lshlrev_b32 v52, 16, v22
    v_and_b32 v53, 0xffff0000, v22
    v_lshlrev_b32 v54, 16, v23
    v_and_b32 v55, 0xffff0000, v23
    s_waitcnt lgkmcnt(0)
    v_add_f32 v64, v64, v72
    v_add_f32 v65, v65, v73
    v_add_f32 v66, v66, v74
    v_add_f32 v67, v67, v75
    v_add_f32 v68, v68, v76
    v_add_f32 v69, v69, v77
    v_add_f32 v70, v70, v78
    v_add_f32 v71, v71, v79
    v_add_f32 v80, v80, v88
    v_add_f32 v81, v81, v89
    v_add_f32 v82, v82, v90
    v_add_f32 v83, v83, v91
    v_add_f32 v84, v84, v92
    v_add_f32 v85, v85, v93
    v_add_f32 v86, v86, v94
    v_add_f32 v87, v87, v95
    v_add_f32 v64, v64, v80
    v_add_f32 v65, v65, v81
    v_add_f32 v66, v66, v82
    v_add_f32 v67, v67, v83
    v_add_f32 v68, v68, v84
    v_add_f32 v69, v69, v85
    v_add_f32 v70, v70, v86
    v_add_f32 v71, v71, v87
    v_fma_f32 v64, v24, s52, v64
    v_fma_f32 v65, v25, s52, v65
    v_fma_f32 v66, v26, s52, v66
    v_fma_f32 v67, v27, s52, v67
    v_fma_f32 v68, v28, s52, v68
    v_fma_f32 v69, v29, s52, v69
    v_fma_f32 v70, v30, s52, v70
    v_fma_f32 v71, v31, s52, v71
    v_fma_f32 v64, v64, v47, v48
    v_fma_f32 v65, v65, v47, v49
    v_fma_f32 v66, v66, v47, v50
    v_fma_f32 v67, v67, v47, v51
    v_fma_f32 v68, v68, v47, v52
    v_fma_f32 v69, v69, v47, v53
    v_fma_f32 v70, v70, v47, v54
    v_fma_f32 v71, v71, v47, v55
    v_cvt_pk_bf16_f32 v64, v64, v65
    v_cvt_pk_bf16_f32 v65, v66, v67
    v_cvt_pk_bf16_f32 v66, v68, v69
    v_cvt_pk_bf16_f32 v67, v70, v71
    buffer_store_dwordx4 v[64:67], v3, s[32:35], s26 offen sc0 sc1
    s_endpgm
L_k2_wp:
    s_load_dwordx2 s[4:5], s[0:1], 64
    s_load_dwordx2 s[8:9], s[0:1], 72
    s_load_dwordx2 s[12:13], s[0:1], 120
    s_sub_u32 s3, s2, 640
    s_mul_hi_u32 s16, s3, 0x33333334
    s_mul_i32 s17, s16, 5
    s_sub_u32 s17, s3, s17
    v_and_b32 v1, 63, v0
    v_lshrrev_b32 v2, 6, v0
    s_nop 0
    v_readfirstlane_b32 s18, v2
    v_lshrrev_b32 v3, 3, v1
    v_and_b32 v4, 7, v1
    v_lshrrev_b32 v5, 4, v1
    v_and_b32 v5, 1, v5
    v_lshlrev_b32 v5, 1, v5
    v_xor_b32 v4, v4, v5
    v_xor_b32 v5, 4, v4
    v_mul_u32_u24 v3, 3072, v3
    v_lshl_add_u32 v4, v4, 4, v3
    v_lshl_add_u32 v5, v5, 4, v3
    s_mul_i32 s19, s17, 128*3072
    s_lshl_b32 s20, s16, 7
    s_add_u32 s19, s19, s20
    s_mul_i32 s20, s18, 4*24576
    s_add_u32 s19, s19, s20
    s_lshl_b32 s21, s18, 12
    s_lshl_b32 s22, s17, 9
    v_lshlrev_b32 v6, 2, v0
    v_add_u32 v6, s22, v6
    s_waitcnt lgkmcnt(0)
    s_mov_b32 s6, 1966080
    s_mov_b32 s7, 0x20000
    s_mov_b32 s10, 1966080
    s_mov_b32 s11, 0x20000
    s_add_u32 s24, s12, 0
    s_addc_u32 s25, s13, 0
    s_mov_b32 s26, 61440
    s_mov_b32 s27, 0x20000
    s_mov_b32 s23, 7680
    buffer_load_dword v8, v6, s[24:27], s23 offen
    buffer_load_dword v12, v6, s[24:27], s23 offen offset:2560
    s_mov_b32 s23, 23040
    buffer_load_dword v9, v6, s[24:27], s23 offen
    buffer_load_dword v13, v6, s[24:27], s23 offen offset:2560
    s_mov_b32 s23, 38400
    buffer_load_dword v10, v6, s[24:27], s23 offen
    buffer_load_dword v14, v6, s[24:27], s23 offen offset:2560
    s_mov_b32 s23, 53760
    buffer_load_dword v11, v6, s[24:27], s23 offen
    buffer_load_dword v15, v6, s[24:27], s23 offen offset:2560
    s_add_u32 m0, s21, 0
    s_add_u32 s23, s19, 0
    buffer_load_dwordx4 v4, s[4:7], s23 offen nt lds
    s_add_u32 m0, s21, 16384
    s_nop 0
    buffer_load_dwordx4 v5, s[8:11], s23 offen nt lds
    s_add_u32 m0, s21, 1024
    s_add_u32 s23, s19, 24576
    buffer_load_dwordx4 v4, s[4:7], s23 offen nt lds
    s_add_u32 m0, s21, 17408
    s_nop 0
    buffer_load_dwordx4 v5, s[8:11], s23 offen nt lds
    s_add_u32 m0, s21, 2048
    s_add_u32 s23, s19, 49152
    buffer_load_dwordx4 v4, s[4:7], s23 offen nt lds
    s_add_u32 m0, s21, 18432
    s_nop 0
    buffer_load_dwordx4 v5, s[8:11], s23 offen nt lds
    s_add_u32 m0, s21, 3072
    s_add_u32 s23, s19, 73728
    buffer_load_dwordx4 v4, s[4:7], s23 offen nt lds
    s_add_u32 m0, s21, 19456
    s_nop 0
    buffer_load_dwordx4 v5, s[8:11], s23 offen nt lds
    s_add_u32 s28, s12, 8126464
    s_addc_u32 s29, s13, 0
    s_mov_b32 s30, 3932160
    s_mov_b32 s31, 0x20000
    s_add_u32 s32, s12, 81920
    s_addc_u32 s33, s13, 0
    s_mov_b32 s34, 122880
    s_mov_b32 s35, 0x20000
    s_waitcnt vmcnt(8)
    v_add_f32 v8, v8, v9
    v_add_f32 v10, v10, v11
    v_add_f32 v12, v12, v13
    v_add_f32 v14, v14, v15
    v_add_f32 v8, v8, v10
    v_add_f32 v12, v12, v14
    v_cvt_pk_bf16_f32 v8, v8, v12
    v_and_b32 v12, 0xffff0000, v8
    v_add_f32 v12, 1.0, v12
    v_cvt_pk_bf16_f32 v12, v12, v12
    v_lshlrev_b32 v12, 16, v12
    v_lshlrev_b32 v9, 2, v0
    v_lshlrev_b32 v10, 1, v0
    v_cmp_gt_u32 vcc, 128, v0
    s_nop 3
    s_and_saveexec_b64 s[36:37], vcc
    v_lshlrev_b32 v8, 16, v8
    ds_write_b32 v9, v12 offset:32768
    ds_write_b32 v9, v8 offset:33280
    s_mov_b64 exec, s[36:37]
    v_lshrrev_b32 v3, 4, v1
    v_and_b32 v7, 15, v1
    v_lshrrev_b32 v8, 2, v7
    v_and_b32 v7, 3, v7
    v_lshrrev_b32 v9, 1, v3
    v_and_b32 v10, 1, v3
    v_lshrrev_b32 v11, 1, v7
    v_lshrrev_b32 v12, 1, v8
    v_lshlrev_b32 v12, 1, v12
    v_xor_b32 v10, v10, v12
    v_lshlrev_b32 v12, 2, v11
    v_xor_b32 v10, v10, v12
    v_lshlrev_b32 v10, 4, v10
    v_lshl_add_u32 v10, v11, 14, v10
    v_lshl_add_u32 v12, v9, 3, v8
    v_lshl_add_u32 v10, v12, 7, v10
    v_and_b32 v12, 1, v7
    v_lshl_add_u32 v10, v12, 3, v10
    s_lshl_b32 s23, s18, 5
    v_xor_b32 v10, s23, v10
    v_lshlrev_b32 v11, 5, v9
    v_lshlrev_b32 v12, 4, v9
    s_lshl_b32 s23, s16, 2
    s_add_u32 s23, s23, s18
    s_mul_i32 s38, s17, 8*96
    s_add_u32 s38, s38, s23
    s_lshl_b32 s38, s38, 10
    v_lshlrev_b32 v13, 4, v1
    s_mov_b32 s39, 0x3f803f80
    v_mov_b32 v14, 0
    v_mov_b32 v15, 0
    v_mov_b32 v98, 0
    v_mov_b32 v99, 0
    s_waitcnt vmcnt(0) lgkmcnt(0)
    s_barrier
    ds_read_b64_tr_b16 v[16:17], v10 offset:0
    ds_read_b64_tr_b16 v[18:19], v10 offset:512
    ds_read_b128 v[20:23], v11 offset:32768
    ds_read_b128 v[24:27], v11 offset:32784
    ds_read_b128 v[28:31], v11 offset:33280
    ds_read_b128 v[32:35], v11 offset:33296
    ds_read_b64_tr_b16 v[52:53], v10 offset:2048
    ds_read_b64_tr_b16 v[54:55], v10 offset:2560
    ds_read_b128 v[56:59], v11 offset:32832
    ds_read_b128 v[60:63], v11 offset:32848
    ds_read_b128 v[64:67], v11 offset:33344
    ds_read_b128 v[68:71], v11 offset:33360
    s_waitcnt lgkmcnt(6)
    v_lshlrev_b32 v36, 16, v16
    v_and_b32 v37, 0xffff0000, v16
    v_lshlrev_b32 v38, 16, v17
    v_and_b32 v39, 0xffff0000, v17
    v_lshlrev_b32 v40, 16, v18
    v_and_b32 v41, 0xffff0000, v18
    v_lshlrev_b32 v42, 16, v19
    v_and_b32 v43, 0xffff0000, v19
    v_fma_f32 v15, v36, v28, v15
    v_fma_f32 v98, v37, v29, v98
    v_fma_f32 v15, v38, v30, v15
    v_fma_f32 v98, v39, v31, v98
    v_fma_f32 v15, v40, v32, v15
    v_fma_f32 v98, v41, v33, v98
    v_fma_f32 v15, v42, v34, v15
    v_fma_f32 v98, v43, v35, v98
    v_mul_f32 v36, v36, v20
    v_mul_f32 v37, v37, v21
    v_mul_f32 v38, v38, v22
    v_mul_f32 v39, v39, v23
    v_mul_f32 v40, v40, v24
    v_mul_f32 v41, v41, v25
    v_mul_f32 v42, v42, v26
    v_mul_f32 v43, v43, v27
    v_cvt_pk_bf16_f32 v44, v36, v37
    v_cvt_pk_bf16_f32 v45, v38, v39
    v_cvt_pk_bf16_f32 v46, v40, v41
    v_cvt_pk_bf16_f32 v47, v42, v43
    v_add_f32 v14, v14, v36
    v_add_f32 v99, v99, v37
    v_add_f32 v14, v14, v38
    v_add_f32 v99, v99, v39
    v_add_f32 v14, v14, v40
    v_add_f32 v99, v99, v41
    v_add_f32 v14, v14, v42
    v_add_f32 v99, v99, v43
    buffer_store_dwordx4 v[44:47], v13, s[28:31], s38 offen sc0 sc1
    s_add_u32 s38, s38, 98304
    ds_read_b64_tr_b16 v[16:17], v10 offset:4096
    ds_read_b64_tr_b16 v[18:19], v10 offset:4608
    ds_read_b128 v[20:23], v11 offset:32896
    ds_read_b128 v[24:27], v11 offset:32912
    ds_read_b128 v[28:31], v11 offset:33408
    ds_read_b128 v[32:35], v11 offset:33424
    s_waitcnt lgkmcnt(6)
    v_lshlrev_b32 v72, 16, v52
    v_and_b32 v73, 0xffff0000, v52
    v_lshlrev_b32 v74, 16, v53
    v_and_b32 v75, 0xffff0000, v53
    v_lshlrev_b32 v76, 16, v54
    v_and_b32 v77, 0xffff0000, v54
    v_lshlrev_b32 v78, 16, v55
    v_and_b32 v79, 0xffff0000, v55
    v_fma_f32 v15, v72, v64, v15
    v_fma_f32 v98, v73, v65, v98
    v_fma_f32 v15, v74, v66, v15
    v_fma_f32 v98, v75, v67, v98
    v_fma_f32 v15, v76, v68, v15
    v_fma_f32 v98, v77, v69, v98
    v_fma_f32 v15, v78, v70, v15
    v_fma_f32 v98, v79, v71, v98
    v_mul_f32 v72, v72, v56
    v_mul_f32 v73, v73, v57
    v_mul_f32 v74, v74, v58
    v_mul_f32 v75, v75, v59
    v_mul_f32 v76, v76, v60
    v_mul_f32 v77, v77, v61
    v_mul_f32 v78, v78, v62
    v_mul_f32 v79, v79, v63
    v_cvt_pk_bf16_f32 v80, v72, v73
    v_cvt_pk_bf16_f32 v81, v74, v75
    v_cvt_pk_bf16_f32 v82, v76, v77
    v_cvt_pk_bf16_f32 v83, v78, v79
    v_add_f32 v14, v14, v72
    v_add_f32 v99, v99, v73
    v_add_f32 v14, v14, v74
    v_add_f32 v99, v99, v75
    v_add_f32 v14, v14, v76
    v_add_f32 v99, v99, v77
    v_add_f32 v14, v14, v78
    v_add_f32 v99, v99, v79
    buffer_store_dwordx4 v[80:83], v13, s[28:31], s38 offen sc0 sc1
    s_add_u32 s38, s38, 98304
    ds_read_b64_tr_b16 v[52:53], v10 offset:6144
    ds_read_b64_tr_b16 v[54:55], v10 offset:6656
    ds_read_b128 v[56:59], v11 offset:32960
    ds_read_b128 v[60:63], v11 offset:32976
    ds_read_b128 v[64:67], v11 offset:33472
    ds_read_b128 v[68:71], v11 offset:33488
    s_waitcnt lgkmcnt(6)
    v_lshlrev_b32 v36, 16, v16
    v_and_b32 v37, 0xffff0000, v16
    v_lshlrev_b32 v38, 16, v17
    v_and_b32 v39, 0xffff0000, v17
    v_lshlrev_b32 v40, 16, v18
    v_and_b32 v41, 0xffff0000, v18
    v_lshlrev_b32 v42, 16, v19
    v_and_b32 v43, 0xffff0000, v19
    v_fma_f32 v15, v36, v28, v15
    v_fma_f32 v98, v37, v29, v98
    v_fma_f32 v15, v38, v30, v15
    v_fma_f32 v98, v39, v31, v98
    v_fma_f32 v15, v40, v32, v15
    v_fma_f32 v98, v41, v33, v98
    v_fma_f32 v15, v42, v34, v15
    v_fma_f32 v98, v43, v35, v98
    v_mul_f32 v36, v36, v20
    v_mul_f32 v37, v37, v21
    v_mul_f32 v38, v38, v22
    v_mul_f32 v39, v39, v23
    v_mul_f32 v40, v40, v24
    v_mul_f32 v41, v41, v25
    v_mul_f32 v42, v42, v26
    v_mul_f32 v43, v43, v27
    v_cvt_pk_bf16_f32 v44, v36, v37
    v_cvt_pk_bf16_f32 v45, v38, v39
    v_cvt_pk_bf16_f32 v46, v40, v41
    v_cvt_pk_bf16_f32 v47, v42, v43
    v_add_f32 v14, v14, v36
    v_add_f32 v99, v99, v37
    v_add_f32 v14, v14, v38
    v_add_f32 v99, v99, v39
    v_add_f32 v14, v14, v40
    v_add_f32 v99, v99, v41
    v_add_f32 v14, v14, v42
    v_add_f32 v99, v99, v43
    buffer_store_dwordx4 v[44:47], v13, s[28:31], s38 offen sc0 sc1
    s_add_u32 s38, s38, 98304
    ds_read_b64_tr_b16 v[16:17], v10 offset:8192
    ds_read_b64_tr_b16 v[18:19], v10 offset:8704
    ds_read_b128 v[20:23], v11 offset:33024
    ds_read_b128 v[24:27], v11 offset:33040
    ds_read_b128 v[28:31], v11 offset:33536
    ds_read_b128 v[32:35], v11 offset:33552
    s_waitcnt lgkmcnt(6)
    v_lshlrev_b32 v72, 16, v52
    v_and_b32 v73, 0xffff0000, v52
    v_lshlrev_b32 v74, 16, v53
    v_and_b32 v75, 0xffff0000, v53
    v_lshlrev_b32 v76, 16, v54
    v_and_b32 v77, 0xffff0000, v54
    v_lshlrev_b32 v78, 16, v55
    v_and_b32 v79, 0xffff0000, v55
    v_fma_f32 v15, v72, v64, v15
    v_fma_f32 v98, v73, v65, v98
    v_fma_f32 v15, v74, v66, v15
    v_fma_f32 v98, v75, v67, v98
    v_fma_f32 v15, v76, v68, v15
    v_fma_f32 v98, v77, v69, v98
    v_fma_f32 v15, v78, v70, v15
    v_fma_f32 v98, v79, v71, v98
    v_mul_f32 v72, v72, v56
    v_mul_f32 v73, v73, v57
    v_mul_f32 v74, v74, v58
    v_mul_f32 v75, v75, v59
    v_mul_f32 v76, v76, v60
    v_mul_f32 v77, v77, v61
    v_mul_f32 v78, v78, v62
    v_mul_f32 v79, v79, v63
    v_cvt_pk_bf16_f32 v80, v72, v73
    v_cvt_pk_bf16_f32 v81, v74, v75
    v_cvt_pk_bf16_f32 v82, v76, v77
    v_cvt_pk_bf16_f32 v83, v78, v79
    v_add_f32 v14, v14, v72
    v_add_f32 v99, v99, v73
    v_add_f32 v14, v14, v74
    v_add_f32 v99, v99, v75
    v_add_f32 v14, v14, v76
    v_add_f32 v99, v99, v77
    v_add_f32 v14, v14, v78
    v_add_f32 v99, v99, v79
    buffer_store_dwordx4 v[80:83], v13, s[28:31], s38 offen sc0 sc1
    s_add_u32 s38, s38, 98304
    ds_read_b64_tr_b16 v[52:53], v10 offset:10240
    ds_read_b64_tr_b16 v[54:55], v10 offset:10752
    ds_read_b128 v[56:59], v11 offset:33088
    ds_read_b128 v[60:63], v11 offset:33104
    ds_read_b128 v[64:67], v11 offset:33600
    ds_read_b128 v[68:71], v11 offset:33616
    s_waitcnt lgkmcnt(6)
    v_lshlrev_b32 v36, 16, v16
    v_and_b32 v37, 0xffff0000, v16
    v_lshlrev_b32 v38, 16, v17
    v_and_b32 v39, 0xffff0000, v17
    v_lshlrev_b32 v40, 16, v18
    v_and_b32 v41, 0xffff0000, v18
    v_lshlrev_b32 v42, 16, v19
    v_and_b32 v43, 0xffff0000, v19
    v_fma_f32 v15, v36, v28, v15
    v_fma_f32 v98, v37, v29, v98
    v_fma_f32 v15, v38, v30, v15
    v_fma_f32 v98, v39, v31, v98
    v_fma_f32 v15, v40, v32, v15
    v_fma_f32 v98, v41, v33, v98
    v_fma_f32 v15, v42, v34, v15
    v_fma_f32 v98, v43, v35, v98
    v_mul_f32 v36, v36, v20
    v_mul_f32 v37, v37, v21
    v_mul_f32 v38, v38, v22
    v_mul_f32 v39, v39, v23
    v_mul_f32 v40, v40, v24
    v_mul_f32 v41, v41, v25
    v_mul_f32 v42, v42, v26
    v_mul_f32 v43, v43, v27
    v_cvt_pk_bf16_f32 v44, v36, v37
    v_cvt_pk_bf16_f32 v45, v38, v39
    v_cvt_pk_bf16_f32 v46, v40, v41
    v_cvt_pk_bf16_f32 v47, v42, v43
    v_add_f32 v14, v14, v36
    v_add_f32 v99, v99, v37
    v_add_f32 v14, v14, v38
    v_add_f32 v99, v99, v39
    v_add_f32 v14, v14, v40
    v_add_f32 v99, v99, v41
    v_add_f32 v14, v14, v42
    v_add_f32 v99, v99, v43
    buffer_store_dwordx4 v[44:47], v13, s[28:31], s38 offen sc0 sc1
    s_add_u32 s38, s38, 98304
    ds_read_b64_tr_b16 v[16:17], v10 offset:12288
    ds_read_b64_tr_b16 v[18:19], v10 offset:12800
    ds_read_b128 v[20:23], v11 offset:33152
    ds_read_b128 v[24:27], v11 offset:33168
    ds_read_b128 v[28:31], v11 offset:33664
    ds_read_b128 v[32:35], v11 offset:33680
    s_waitcnt lgkmcnt(6)
    v_lshlrev_b32 v72, 16, v52
    v_and_b32 v73, 0xffff0000, v52
    v_lshlrev_b32 v74, 16, v53
    v_and_b32 v75, 0xffff0000, v53
    v_lshlrev_b32 v76, 16, v54
    v_and_b32 v77, 0xffff0000, v54
    v_lshlrev_b32 v78, 16, v55
    v_and_b32 v79, 0xffff0000, v55
    v_fma_f32 v15, v72, v64, v15
    v_fma_f32 v98, v73, v65, v98
    v_fma_f32 v15, v74, v66, v15
    v_fma_f32 v98, v75, v67, v98
    v_fma_f32 v15, v76, v68, v15
    v_fma_f32 v98, v77, v69, v98
    v_fma_f32 v15, v78, v70, v15
    v_fma_f32 v98, v79, v71, v98
    v_mul_f32 v72, v72, v56
    v_mul_f32 v73, v73, v57
    v_mul_f32 v74, v74, v58
    v_mul_f32 v75, v75, v59
    v_mul_f32 v76, v76, v60
    v_mul_f32 v77, v77, v61
    v_mul_f32 v78, v78, v62
    v_mul_f32 v79, v79, v63
    v_cvt_pk_bf16_f32 v80, v72, v73
    v_cvt_pk_bf16_f32 v81, v74, v75
    v_cvt_pk_bf16_f32 v82, v76, v77
    v_cvt_pk_bf16_f32 v83, v78, v79
    v_add_f32 v14, v14, v72
    v_add_f32 v99, v99, v73
    v_add_f32 v14, v14, v74
    v_add_f32 v99, v99, v75
    v_add_f32 v14, v14, v76
    v_add_f32 v99, v99, v77
    v_add_f32 v14, v14, v78
    v_add_f32 v99, v99, v79
    buffer_store_dwordx4 v[80:83], v13, s[28:31], s38 offen sc0 sc1
    s_add_u32 s38, s38, 98304
    ds_read_b64_tr_b16 v[52:53], v10 offset:14336
    ds_read_b64_tr_b16 v[54:55], v10 offset:14848
    ds_read_b128 v[56:59], v11 offset:33216
    ds_read_b128 v[60:63], v11 offset:33232
    ds_read_b128 v[64:67], v11 offset:33728
    ds_read_b128 v[68:71], v11 offset:33744
    s_waitcnt lgkmcnt(6)
    v_lshlrev_b32 v36, 16, v16
    v_and_b32 v37, 0xffff0000, v16
    v_lshlrev_b32 v38, 16, v17
    v_and_b32 v39, 0xffff0000, v17
    v_lshlrev_b32 v40, 16, v18
    v_and_b32 v41, 0xffff0000, v18
    v_lshlrev_b32 v42, 16, v19
    v_and_b32 v43, 0xffff0000, v19
    v_fma_f32 v15, v36, v28, v15
    v_fma_f32 v98, v37, v29, v98
    v_fma_f32 v15, v38, v30, v15
    v_fma_f32 v98, v39, v31, v98
    v_fma_f32 v15, v40, v32, v15
    v_fma_f32 v98, v41, v33, v98
    v_fma_f32 v15, v42, v34, v15
    v_fma_f32 v98, v43, v35, v98
    v_mul_f32 v36, v36, v20
    v_mul_f32 v37, v37, v21
    v_mul_f32 v38, v38, v22
    v_mul_f32 v39, v39, v23
    v_mul_f32 v40, v40, v24
    v_mul_f32 v41, v41, v25
    v_mul_f32 v42, v42, v26
    v_mul_f32 v43, v43, v27
    v_cvt_pk_bf16_f32 v44, v36, v37
    v_cvt_pk_bf16_f32 v45, v38, v39
    v_cvt_pk_bf16_f32 v46, v40, v41
    v_cvt_pk_bf16_f32 v47, v42, v43
    v_add_f32 v14, v14, v36
    v_add_f32 v99, v99, v37
    v_add_f32 v14, v14, v38
    v_add_f32 v99, v99, v39
    v_add_f32 v14, v14, v40
    v_add_f32 v99, v99, v41
    v_add_f32 v14, v14, v42
    v_add_f32 v99, v99, v43
    buffer_store_dwordx4 v[44:47], v13, s[28:31], s38 offen sc0 sc1
    s_add_u32 s38, s38, 98304
    s_waitcnt lgkmcnt(0)
    v_lshlrev_b32 v72, 16, v52
    v_and_b32 v73, 0xffff0000, v52
    v_lshlrev_b32 v74, 16, v53
    v_and_b32 v75, 0xffff0000, v53
    v_lshlrev_b32 v76, 16, v54
    v_and_b32 v77, 0xffff0000, v54
    v_lshlrev_b32 v78, 16, v55
    v_and_b32 v79, 0xffff0000, v55
    v_fma_f32 v15, v72, v64, v15
    v_fma_f32 v98, v73, v65, v98
    v_fma_f32 v15, v74, v66, v15
    v_fma_f32 v98, v75, v67, v98
    v_fma_f32 v15, v76, v68, v15
    v_fma_f32 v98, v77, v69, v98
    v_fma_f32 v15, v78, v70, v15
    v_fma_f32 v98, v79, v71, v98
    v_mul_f32 v72, v72, v56
    v_mul_f32 v73, v73, v57
    v_mul_f32 v74, v74, v58
    v_mul_f32 v75, v75, v59
    v_mul_f32 v76, v76, v60
    v_mul_f32 v77, v77, v61
    v_mul_f32 v78, v78, v62
    v_mul_f32 v79, v79, v63
    v_cvt_pk_bf16_f32 v80, v72, v73
    v_cvt_pk_bf16_f32 v81, v74, v75
    v_cvt_pk_bf16_f32 v82, v76, v77
    v_cvt_pk_bf16_f32 v83, v78, v79
    v_add_f32 v14, v14, v72
    v_add_f32 v99, v99, v73
    v_add_f32 v14, v14, v74
    v_add_f32 v99, v99, v75
    v_add_f32 v14, v14, v76
    v_add_f32 v99, v99, v77
    v_add_f32 v14, v14, v78
    v_add_f32 v99, v99, v79
    buffer_store_dwordx4 v[80:83], v13, s[28:31], s38 offen sc0 sc1
    s_add_u32 s38, s38, 98304
    v_add_f32 v14, v14, v99
    v_add_f32 v15, v15, v98
    v_mov_b32 v16, v14
    v_mov_b32 v17, v15
    s_nop 0
    v_permlane32_swap_b32 v14, v16
    v_permlane32_swap_b32 v15, v17
    v_add_f32 v14, v14, v16
    v_add_f32 v15, v15, v17
    s_mul_i32 s38, s17, 96
    s_add_u32 s38, s38, s23
    s_lshl_b32 s38, s38, 8
    v_lshlrev_b32 v13, 3, v1
    v_cmp_gt_u32 vcc, 32, v1
    s_nop 3
    s_and_saveexec_b64 s[36:37], vcc
    buffer_store_dwordx2 v[14:15], v13, s[32:35], s38 offen sc0 sc1
    s_mov_b64 exec, s[36:37]
    s_endpgm
L_k2_wd:
    s_load_dwordx2 s[4:5], s[0:1], 80
    s_load_dwordx2 s[8:9], s[0:1], 120
    s_sub_u32 s3, s2, 760
    v_and_b32 v1, 63, v0
    v_lshrrev_b32 v2, 6, v0
    v_lshlrev_b32 v3, 4, v1
    v_readfirstlane_b32 s16, v2
    s_mul_i32 s17, s3, 40960
    s_nop 2
    s_mul_i32 s18, s16, 10240
    s_add_u32 s17, s17, s18
    s_waitcnt lgkmcnt(0)
    s_mov_b32 s6, 1966080
    s_mov_b32 s7, 0x20000
    s_add_u32 s12, s8, 18546688
    s_addc_u32 s13, s9, 0
    s_mov_b32 s14, 1966080
    s_mov_b32 s15, 0x20000
    s_add_u32 m0, s18, 0
    s_add_u32 s19, s17, 0
    buffer_load_dwordx4 v3, s[4:7], s19 offen nt lds
    s_add_u32 m0, s18, 1024
    s_add_u32 s19, s17, 1024
    buffer_load_dwordx4 v3, s[4:7], s19 offen nt lds
    s_add_u32 m0, s18, 2048
    s_add_u32 s19, s17, 2048
    buffer_load_dwordx4 v3, s[4:7], s19 offen nt lds
    s_add_u32 m0, s18, 3072
    s_add_u32 s19, s17, 3072
    buffer_load_dwordx4 v3, s[4:7], s19 offen nt lds
    s_add_u32 m0, s18, 4096
    s_add_u32 s19, s17, 4096
    buffer_load_dwordx4 v3, s[4:7], s19 offen nt lds
    s_add_u32 m0, s18, 5120
    s_add_u32 s19, s17, 5120
    buffer_load_dwordx4 v3, s[4:7], s19 offen nt lds
    s_add_u32 m0, s18, 6144
    s_add_u32 s19, s17, 6144
    buffer_load_dwordx4 v3, s[4:7], s19 offen nt lds
    s_add_u32 m0, s18, 7168
    s_add_u32 s19, s17, 7168
    buffer_load_dwordx4 v3, s[4:7], s19 offen nt lds
    s_add_u32 m0, s18, 8192
    s_add_u32 s19, s17, 8192
    buffer_load_dwordx4 v3, s[4:7], s19 offen nt lds
    s_add_u32 m0, s18, 9216
    s_add_u32 s19, s17, 9216
    buffer_load_dwordx4 v3, s[4:7], s19 offen nt lds
    v_lshrrev_b32 v5, 4, v1
    v_and_b32 v6, 15, v1
    v_lshrrev_b32 v7, 2, v6
    v_and_b32 v6, 3, v6
    v_lshrrev_b32 v12, 1, v5
    v_lshlrev_b32 v12, 4, v12
    v_and_b32 v13, 1, v5
    v_lshl_add_u32 v12, v13, 2, v12
    v_add_u32 v12, v12, v7
    v_mul_u32_u24 v12, 1280, v12
    v_lshl_add_u32 v12, v6, 3, v12
    s_mul_i32 s24, s16, 320
    v_add_u32 v12, s24, v12
    s_mul_i32 s24, s16, 96
    s_add_u32 s24, s24, s3
    s_mul_i32 s24, s24, 5120
    s_waitcnt vmcnt(0)
    s_barrier
    ds_read_b64_tr_b16 v[16:17], v12 offset:0
    ds_read_b64_tr_b16 v[18:19], v12 offset:10240
    ds_read_b64_tr_b16 v[20:21], v12 offset:32
    ds_read_b64_tr_b16 v[22:23], v12 offset:10272
    ds_read_b64_tr_b16 v[24:25], v12 offset:64
    ds_read_b64_tr_b16 v[26:27], v12 offset:10304
    ds_read_b64_tr_b16 v[28:29], v12 offset:96
    ds_read_b64_tr_b16 v[30:31], v12 offset:10336
    ds_read_b64_tr_b16 v[32:33], v12 offset:128
    ds_read_b64_tr_b16 v[34:35], v12 offset:10368
    ds_read_b64_tr_b16 v[36:37], v12 offset:160
    ds_read_b64_tr_b16 v[38:39], v12 offset:10400
    ds_read_b64_tr_b16 v[40:41], v12 offset:192
    ds_read_b64_tr_b16 v[42:43], v12 offset:10432
    ds_read_b64_tr_b16 v[44:45], v12 offset:224
    ds_read_b64_tr_b16 v[46:47], v12 offset:10464
    ds_read_b64_tr_b16 v[48:49], v12 offset:256
    ds_read_b64_tr_b16 v[50:51], v12 offset:10496
    ds_read_b64_tr_b16 v[52:53], v12 offset:288
    ds_read_b64_tr_b16 v[54:55], v12 offset:10528
    s_waitcnt lgkmcnt(15)
    s_add_u32 s25, s24, 0
    buffer_store_dwordx4 v[16:19], v3, s[12:15], s25 offen sc0 sc1
    s_waitcnt lgkmcnt(15)
    s_add_u32 s25, s24, 1024
    buffer_store_dwordx4 v[20:23], v3, s[12:15], s25 offen sc0 sc1
    s_waitcnt lgkmcnt(14)
    s_add_u32 s25, s24, 2048
    buffer_store_dwordx4 v[24:27], v3, s[12:15], s25 offen sc0 sc1
    s_waitcnt lgkmcnt(12)
    s_add_u32 s25, s24, 3072
    buffer_store_dwordx4 v[28:31], v3, s[12:15], s25 offen sc0 sc1
    s_waitcnt lgkmcnt(10)
    s_add_u32 s25, s24, 4096
    buffer_store_dwordx4 v[32:35], v3, s[12:15], s25 offen sc0 sc1
    s_waitcnt lgkmcnt(8)
    s_add_u32 s25, s24, 245760
    buffer_store_dwordx4 v[36:39], v3, s[12:15], s25 offen sc0 sc1
    s_waitcnt lgkmcnt(6)
    s_add_u32 s25, s24, 246784
    buffer_store_dwordx4 v[40:43], v3, s[12:15], s25 offen sc0 sc1
    s_waitcnt lgkmcnt(4)
    s_add_u32 s25, s24, 247808
    buffer_store_dwordx4 v[44:47], v3, s[12:15], s25 offen sc0 sc1
    s_waitcnt lgkmcnt(2)
    s_add_u32 s25, s24, 248832
    buffer_store_dwordx4 v[48:51], v3, s[12:15], s25 offen sc0 sc1
    s_waitcnt lgkmcnt(0)
    s_add_u32 s25, s24, 249856
    buffer_store_dwordx4 v[52:55], v3, s[12:15], s25 offen sc0 sc1
    s_endpgm

.globl ffn_kernel
.p2align 8
.type ffn_kernel,@function
ffn_kernel:
    s_cmp_ge_u32 s2, 256
    s_cbranch_scc1 L_k5_exit
    s_load_dwordx2 s[4:5], s[0:1], 120
    s_load_dwordx2 s[82:83], s[0:1], 104
    v_lshrrev_b32 v2, 6, v0
    v_and_b32 v1, 63, v0
    v_readfirstlane_b32 s22, v2
    s_and_b32 s80, s2, 7
    s_lshr_b32 s81, s2, 3
    s_and_b32 s20, s80, 1
    s_lshl_b32 s20, s20, 3
    s_and_b32 s21, s81, 7
    s_add_u32 s20, s20, s21
    s_lshr_b32 s21, s80, 1
    s_lshl_b32 s21, s21, 2
    s_lshr_b32 s27, s81, 3
    s_add_u32 s21, s21, s27
    s_lshr_b32 s3, s80, 1
    s_and_b32 s3, s3, 1
    s_lshl_b32 s6, s20, 1
    s_add_u32 s3, s3, s6
    s_lshr_b32 s6, s80, 2
    s_lshl_b32 s6, s6, 2
    s_add_u32 s27, s27, s6
    v_lshrrev_b32 v3, 4, v1
    v_and_b32 v4, 15, v1
    v_lshlrev_b32 v5, 2, v3
    v_xor_b32 v5, v5, v4
    v_lshlrev_b32 v5, 4, v5
    v_lshl_add_u32 v5, v3, 12, v5
    s_lshl_b32 s6, s20, 8
    v_add_u32 v5, s6, v5
    v_add_u32 v6, 16384, v5
    v_lshlrev_b32 v7, 4, v1
    s_lshr_b32 s23, s22, 1
    s_and_b32 s24, s22, 1
    s_mul_i32 s80, s20, 0
    s_add_u32 s80, s80, s21
    s_lshl_b32 s80, s80, 1
    s_cmp_lt_u32 s21, 10
    s_cselect_b32 s81, 0, 1
    s_add_u32 s80, s80, s81
    s_mul_hi_u32 s81, s80, 0x0CCCCCCD
    s_mul_i32 s81, s81, 20
    s_sub_u32 s80, s80, s81
    s_lshl_b32 s84, s22, 15
    s_mul_i32 s85, s23, 96
    s_mul_i32 s81, s21, 6
    s_add_u32 s85, s85, s81
    s_mul_i32 s81, s24, 3
    s_add_u32 s85, s85, s81
    s_lshl_b32 s85, s85, 10
    s_mul_i32 s36, s80, 131072
    s_mul_i32 s56, s80, 196608
    s_add_u32 s36, s36, s84
    s_add_u32 s56, s56, s85
    s_add_u32 s80, s80, 1
    s_cmp_eq_u32 s80, 20
    s_cselect_b32 s80, 0, s80
    s_lshl_b32 s6, s22, 11
    s_mul_i32 s7, s22, 3072
    s_add_u32 s7, s7, 8192
    s_mul_i32 s37, s80, 131072
    s_mul_i32 s57, s80, 196608
    s_add_u32 s37, s37, s84
    s_add_u32 s57, s57, s85
    s_add_u32 s80, s80, 1
    s_cmp_eq_u32 s80, 20
    s_cselect_b32 s80, 0, s80
    s_waitcnt lgkmcnt(0)
    s_add_u32 s8, s4, 5505024
    s_addc_u32 s9, s5, 0
    s_mov_b32 s10, 2621440
    s_mov_b32 s11, 0x20000
    s_add_u32 s12, s4, 8126464
    s_addc_u32 s13, s5, 0
    s_mov_b32 s14, 3932160
    s_mov_b32 s15, 0x20000
    s_add_u32 m0, s6, 0
    s_nop 0
    buffer_load_dwordx4 v5, s[8:11], s36 offen lds
    s_mul_i32 s38, s80, 131072
    s_mul_i32 s58, s80, 196608
    s_add_u32 s38, s38, s84
    s_add_u32 s58, s58, s85
    s_add_u32 s80, s80, 1
    s_cmp_eq_u32 s80, 20
    s_cselect_b32 s80, 0, s80
    s_add_u32 m0, s6, 1024
    s_nop 0
    buffer_load_dwordx4 v6, s[8:11], s36 offen lds
    s_mul_i32 s39, s80, 131072
    s_mul_i32 s59, s80, 196608
    s_add_u32 s39, s39, s84
    s_add_u32 s59, s59, s85
    s_add_u32 s80, s80, 1
    s_cmp_eq_u32 s80, 20
    s_cselect_b32 s80, 0, s80
    s_add_u32 m0, s7, 0
    s_nop 0
    buffer_load_dwordx4 v7, s[12:15], s56 offen lds
    s_mul_i32 s40, s80, 131072
    s_mul_i32 s60, s80, 196608
    s_add_u32 s40, s40, s84
    s_add_u32 s60, s60, s85
    s_add_u32 s80, s80, 1
    s_cmp_eq_u32 s80, 20
    s_cselect_b32 s80, 0, s80
    buffer_load_dwordx4 v7, s[12:15], s56 offen offset:1024 lds
    s_mul_i32 s41, s80, 131072
    s_mul_i32 s61, s80, 196608
    s_add_u32 s41, s41, s84
    s_add_u32 s61, s61, s85
    s_add_u32 s80, s80, 1
    s_cmp_eq_u32 s80, 20
    s_cselect_b32 s80, 0, s80
    buffer_load_dwordx4 v7, s[12:15], s56 offen offset:2048 lds
    s_mul_i32 s42, s80, 131072
    s_mul_i32 s62, s80, 196608
    s_add_u32 s42, s42, s84
    s_add_u32 s62, s62, s85
    s_add_u32 s80, s80, 1
    s_cmp_eq_u32 s80, 20
    s_cselect_b32 s80, 0, s80
    s_add_u32 m0, s6, 20480
    s_nop 0
    buffer_load_dwordx4 v5, s[8:11], s37 offen lds
    s_mul_i32 s43, s80, 131072
    s_mul_i32 s63, s80, 196608
    s_add_u32 s43, s43, s84
    s_add_u32 s63, s63, s85
    s_add_u32 s80, s80, 1
    s_cmp_eq_u32 s80, 20
    s_cselect_b32 s80, 0, s80
    s_add_u32 m0, s6, 21504
    s_nop 0
    buffer_load_dwordx4 v6, s[8:11], s37 offen lds
    s_mul_i32 s44, s80, 131072
    s_mul_i32 s64, s80, 196608
    s_add_u32 s44, s44, s84
    s_add_u32 s64, s64, s85
    s_add_u32 s80, s80, 1
    s_cmp_eq_u32 s80, 20
    s_cselect_b32 s80, 0, s80
    s_add_u32 m0, s7, 20480
    s_nop 0
    buffer_load_dwordx4 v7, s[12:15], s57 offen lds
    s_mul_i32 s45, s80, 131072
    s_mul_i32 s65, s80, 196608
    s_add_u32 s45, s45, s84
    s_add_u32 s65, s65, s85
    s_add_u32 s80, s80, 1
    s_cmp_eq_u32 s80, 20
    s_cselect_b32 s80, 0, s80
    buffer_load_dwordx4 v7, s[12:15], s57 offen offset:1024 lds
    s_mul_i32 s46, s80, 131072
    s_mul_i32 s66, s80, 196608
    s_add_u32 s46, s46, s84
    s_add_u32 s66, s66, s85
    s_add_u32 s80, s80, 1
    s_cmp_eq_u32 s80, 20
    s_cselect_b32 s80, 0, s80
    buffer_load_dwordx4 v7, s[12:15], s57 offen offset:2048 lds
    s_mul_i32 s47, s80, 131072
    s_mul_i32 s67, s80, 196608
    s_add_u32 s47, s47, s84
    s_add_u32 s67, s67, s85
    s_add_u32 s80, s80, 1
    s_cmp_eq_u32 s80, 20
    s_cselect_b32 s80, 0, s80
    s_add_u32 m0, s6, 40960
    s_nop 0
    buffer_load_dwordx4 v5, s[8:11], s38 offen lds
    s_mul_i32 s48, s80, 131072
    s_mul_i32 s68, s80, 196608
    s_add_u32 s48, s48, s84
    s_add_u32 s68, s68, s85
    s_add_u32 s80, s80, 1
    s_cmp_eq_u32 s80, 20
    s_cselect_b32 s80, 0, s80
    s_add_u32 m0, s6, 41984
    s_nop 0
    buffer_load_dwordx4 v6, s[8:11], s38 offen lds
    s_mul_i32 s49, s80, 131072
    s_mul_i32 s69, s80, 196608
    s_add_u32 s49, s49, s84
    s_add_u32 s69, s69, s85
    s_add_u32 s80, s80, 1
    s_cmp_eq_u32 s80, 20
    s_cselect_b32 s80, 0, s80
    s_add_u32 m0, s7, 40960
    s_nop 0
    buffer_load_dwordx4 v7, s[12:15], s58 offen lds
    s_mul_i32 s50, s80, 131072
    s_mul_i32 s70, s80, 196608
    s_add_u32 s50, s50, s84
    s_add_u32 s70, s70, s85
    s_add_u32 s80, s80, 1
    s_cmp_eq_u32 s80, 20
    s_cselect_b32 s80, 0, s80
    buffer_load_dwordx4 v7, s[12:15], s58 offen offset:1024 lds
    s_mul_i32 s51, s80, 131072
    s_mul_i32 s71, s80, 196608
    s_add_u32 s51, s51, s84
    s_add_u32 s71, s71, s85
    s_add_u32 s80, s80, 1
    s_cmp_eq_u32 s80, 20
    s_cselect_b32 s80, 0, s80
    buffer_load_dwordx4 v7, s[12:15], s58 offen offset:2048 lds
    s_mul_i32 s52, s80, 131072
    s_mul_i32 s72, s80, 196608
    s_add_u32 s52, s52, s84
    s_add_u32 s72, s72, s85
    s_add_u32 s80, s80, 1
    s_cmp_eq_u32 s80, 20
    s_cselect_b32 s80, 0, s80
    s_add_u32 m0, s6, 61440
    s_nop 0
    buffer_load_dwordx4 v5, s[8:11], s39 offen lds
    s_mul_i32 s53, s80, 131072
    s_mul_i32 s73, s80, 196608
    s_add_u32 s53, s53, s84
    s_add_u32 s73, s73, s85
    s_add_u32 s80, s80, 1
    s_cmp_eq_u32 s80, 20
    s_cselect_b32 s80, 0, s80
    s_add_u32 m0, s6, 62464
    s_nop 0
    buffer_load_dwordx4 v6, s[8:11], s39 offen lds
    s_mul_i32 s54, s80, 131072
    s_mul_i32 s74, s80, 196608
    s_add_u32 s54, s54, s84
    s_add_u32 s74, s74, s85
    s_add_u32 s80, s80, 1
    s_cmp_eq_u32 s80, 20
    s_cselect_b32 s80, 0, s80
    s_add_u32 m0, s7, 61440
    s_nop 0
    buffer_load_dwordx4 v7, s[12:15], s59 offen lds
    s_mul_i32 s55, s80, 131072
    s_mul_i32 s75, s80, 196608
    s_add_u32 s55, s55, s84
    s_add_u32 s75, s75, s85
    s_add_u32 s80, s80, 1
    s_cmp_eq_u32 s80, 20
    s_cselect_b32 s80, 0, s80
    buffer_load_dwordx4 v7, s[12:15], s59 offen offset:1024 lds
    v_mov_b32 v29, 0x80000000
    v_lshrrev_b32 v18, 2, v4
    v_and_b32 v19, 3, v4
    v_lshrrev_b32 v20, 1, v3
    v_and_b32 v21, 1, v3
    v_lshl_add_u32 v22, v20, 3, v18
    v_lshlrev_b32 v22, 8, v22
    buffer_load_dwordx4 v7, s[12:15], s59 offen offset:2048 lds
    v_lshrrev_b32 v23, 1, v19
    v_lshl_add_u32 v23, v21, 1, v23
    v_lshl_add_u32 v22, v23, 4, v22
    v_and_b32 v23, 1, v19
    v_lshl_add_u32 v22, v23, 3, v22
    s_lshl_b32 s25, s23, 1
    s_add_u32 s25, s25, s24
    s_add_u32 m0, s6, 81920
    s_nop 0
    buffer_load_dwordx4 v5, s[8:11], s40 offen lds
    s_xor_b32 s26, s25, 1
    v_xor_b32 v23, s25, v18
    v_lshl_add_u32 v8, v23, 6, v22
    v_xor_b32 v23, s26, v18
    v_lshl_add_u32 v9, v23, 6, v22
    s_mul_i32 s81, s24, 3072
    s_add_u32 s81, s81, 8192
    s_add_u32 m0, s6, 82944
    s_nop 0
    buffer_load_dwordx4 v6, s[8:11], s40 offen lds
    v_add_u32 v10, s81, v7
    v_add_u32 v11, 61440, v8
    v_add_u32 v12, 61440, v9
    v_add_u32 v13, 61440, v10
    v_add_u32 v14, 122880, v8
    v_add_u32 v15, 122880, v9
    v_add_u32 v16, 122880, v10
    s_add_u32 m0, s7, 81920
    s_nop 0
    buffer_load_dwordx4 v7, s[12:15], s60 offen lds
    s_add_u32 s16, s4, 12058624
    s_addc_u32 s17, s5, 0
    s_mov_b32 s18, 6291456
    s_mov_b32 s19, 0x20000
    s_add_u32 s28, s4, 18350080
    s_addc_u32 s29, s5, 0
    s_mov_b32 s30, 2555904
    buffer_load_dwordx4 v7, s[12:15], s60 offen offset:1024 lds
    s_mov_b32 s31, 0x20000
    s_add_u32 s32, s4, 18546688
    s_addc_u32 s33, s5, 0
    s_mov_b32 s34, 1966080
    s_mov_b32 s35, 0x20000
    buffer_load_dwordx4 v7, s[12:15], s60 offen offset:2048 lds
    s_mul_i32 s84, s27, 48
    s_add_u32 s84, s84, s22
    s_mul_i32 s84, s84, 5120
    s_waitcnt vmcnt(20)
    s_barrier
    ds_read_b64_tr_b16 v[32:33], v8 offset:0
    ds_read_b64_tr_b16 v[34:35], v8 offset:1024
    ds_read_b128 v[40:43], v10 offset:0
    ds_read_b64_tr_b16 v[36:37], v9 offset:0
    ds_read_b64_tr_b16 v[38:39], v9 offset:1024
    ds_read_b128 v[44:47], v10 offset:1024
    ds_read_b128 v[48:51], v10 offset:2048
    s_add_u32 m0, s6, 102400
    s_nop 0
    buffer_load_dwordx4 v5, s[8:11], s41 offen lds
    s_add_u32 m0, s6, 103424
    s_nop 0
    buffer_load_dwordx4 v6, s[8:11], s41 offen lds
    s_waitcnt lgkmcnt(4)
    v_mfma_f32_32x32x16_bf16 v[96:111], v[40:43], v[32:35], 0
    ds_read_b64_tr_b16 v[52:53], v8 offset:4096
    ds_read_b64_tr_b16 v[54:55], v8 offset:5120
    v_lshlrev_b32 v88, 16, v32
    v_and_b32 v89, 0xffff0000, v32
    s_add_u32 m0, s7, 102400
    s_waitcnt lgkmcnt(4)
    v_mfma_f32_32x32x16_bf16 v[144:159], v[40:43], v[36:39], 0
    buffer_load_dwordx4 v7, s[12:15], s61 offen lds
    ds_read_b128 v[60:63], v10 offset:6144
    s_waitcnt lgkmcnt(4)
    v_mfma_f32_32x32x16_bf16 v[112:127], v[44:47], v[32:35], 0
    ds_read_b64_tr_b16 v[56:57], v9 offset:4096
    ds_read_b64_tr_b16 v[58:59], v9 offset:5120
    v_mov_b32 v84, v88
    v_mov_b32 v85, v89
    v_mul_f32 v86, v88, v88
    v_mfma_f32_32x32x16_bf16 v[160:175], v[44:47], v[36:39], 0
    buffer_load_dwordx4 v7, s[12:15], s61 offen offset:1024 lds
    ds_read_b128 v[64:67], v10 offset:7168
    s_waitcnt lgkmcnt(6)
    v_mfma_f32_32x32x16_bf16 v[128:143], v[48:51], v[32:35], 0
    ds_read_b128 v[68:71], v10 offset:8192
    v_mul_f32 v87, v89, v89
    v_lshlrev_b32 v90, 16, v33
    v_and_b32 v91, 0xffff0000, v33
    v_add_f32 v84, v84, v90
    v_mfma_f32_32x32x16_bf16 v[176:191], v[48:51], v[36:39], 0
    buffer_load_dwordx4 v7, s[12:15], s61 offen offset:2048 lds
    v_add_f32 v85, v85, v91
    v_fma_f32 v86, v90, v90, v86
    v_fma_f32 v87, v91, v91, v87
    v_lshlrev_b32 v88, 16, v34
    v_and_b32 v89, 0xffff0000, v34
    v_add_f32 v84, v84, v88
    v_add_f32 v85, v85, v89
    v_fma_f32 v86, v88, v88, v86
    v_fma_f32 v87, v89, v89, v87
    v_lshlrev_b32 v90, 16, v35
    v_and_b32 v91, 0xffff0000, v35
    v_add_f32 v84, v84, v90
    v_add_f32 v85, v85, v91
    v_fma_f32 v86, v90, v90, v86
    v_fma_f32 v87, v91, v91, v87
    s_waitcnt vmcnt(20)
    s_barrier
    s_waitcnt lgkmcnt(4)
    v_mfma_f32_32x32x16_bf16 v[96:111], v[60:63], v[52:55], v[96:111]
    ds_read_b64_tr_b16 v[32:33], v8 offset:20480
    ds_read_b64_tr_b16 v[34:35], v8 offset:21504
    v_lshlrev_b32 v88, 16, v52
    v_and_b32 v89, 0xffff0000, v52
    s_add_u32 m0, s6, 122880
    s_waitcnt lgkmcnt(4)
    v_mfma_f32_32x32x16_bf16 v[144:159], v[60:63], v[56:59], v[144:159]
    buffer_load_dwordx4 v5, s[8:11], s42 offen lds
    ds_read_b128 v[40:43], v10 offset:20480
    s_waitcnt lgkmcnt(4)
    v_mfma_f32_32x32x16_bf16 v[112:127], v[64:67], v[52:55], v[112:127]
    ds_read_b64_tr_b16 v[36:37], v9 offset:20480
    ds_read_b64_tr_b16 v[38:39], v9 offset:21504
    v_add_f32 v84, v84, v88
    v_add_f32 v85, v85, v89
    s_add_u32 m0, s6, 123904
    v_mfma_f32_32x32x16_bf16 v[160:175], v[64:67], v[56:59], v[160:175]
    buffer_load_dwordx4 v6, s[8:11], s42 offen lds
    ds_read_b128 v[44:47], v10 offset:21504
    s_waitcnt lgkmcnt(6)
    v_mfma_f32_32x32x16_bf16 v[128:143], v[68:71], v[52:55], v[128:143]
    ds_read_b128 v[48:51], v10 offset:22528
    v_fma_f32 v86, v88, v88, v86
    v_fma_f32 v87, v89, v89, v87
    v_lshlrev_b32 v90, 16, v53
    v_and_b32 v91, 0xffff0000, v53
    v_mfma_f32_32x32x16_bf16 v[176:191], v[68:71], v[56:59], v[176:191]
    v_add_f32 v84, v84, v90
    v_add_f32 v85, v85, v91
    v_fma_f32 v86, v90, v90, v86
    v_fma_f32 v87, v91, v91, v87
    v_lshlrev_b32 v88, 16, v54
    v_and_b32 v89, 0xffff0000, v54
    v_add_f32 v84, v84, v88
    v_add_f32 v85, v85, v89
    v_fma_f32 v86, v88, v88, v86
    v_fma_f32 v87, v89, v89, v87
    v_lshlrev_b32 v90, 16, v55
    v_and_b32 v91, 0xffff0000, v55
    v_add_f32 v84, v84, v90
    v_add_f32 v85, v85, v91
    v_fma_f32 v86, v90, v90, v86
    v_fma_f32 v87, v91, v91, v87
    s_waitcnt lgkmcnt(4)
    v_mfma_f32_32x32x16_bf16 v[96:111], v[40:43], v[32:35], v[96:111]
    ds_read_b64_tr_b16 v[52:53], v8 offset:24576
    ds_read_b64_tr_b16 v[54:55], v8 offset:25600
    v_lshlrev_b32 v88, 16, v32
    v_and_b32 v89, 0xffff0000, v32
    s_add_u32 m0, s7, 122880
    s_waitcnt lgkmcnt(4)
    v_mfma_f32_32x32x16_bf16 v[144:159], v[40:43], v[36:39], v[144:159]
    buffer_load_dwordx4 v7, s[12:15], s62 offen lds
    ds_read_b128 v[60:63], v10 offset:26624
    s_waitcnt lgkmcnt(4)
    v_mfma_f32_32x32x16_bf16 v[112:127], v[44:47], v[32:35], v[112:127]
    ds_read_b64_tr_b16 v[56:57], v9 offset:24576
    ds_read_b64_tr_b16 v[58:59], v9 offset:25600
    v_add_f32 v84, v84, v88
    v_add_f32 v85, v85, v89
    v_fma_f32 v86, v88, v88, v86
    v_mfma_f32_32x32x16_bf16 v[160:175], v[44:47], v[36:39], v[160:175]
    buffer_load_dwordx4 v7, s[12:15], s62 offen offset:1024 lds
    ds_read_b128 v[64:67], v10 offset:27648
    s_waitcnt lgkmcnt(6)
    v_mfma_f32_32x32x16_bf16 v[128:143], v[48:51], v[32:35], v[128:143]
    ds_read_b128 v[68:71], v10 offset:28672
    v_fma_f32 v87, v89, v89, v87
    v_lshlrev_b32 v90, 16, v33
    v_and_b32 v91, 0xffff0000, v33
    v_add_f32 v84, v84, v90
    v_mfma_f32_32x32x16_bf16 v[176:191], v[48:51], v[36:39], v[176:191]
    buffer_load_dwordx4 v7, s[12:15], s62 offen offset:2048 lds
    v_add_f32 v85, v85, v91
    v_fma_f32 v86, v90, v90, v86
    v_fma_f32 v87, v91, v91, v87
    v_lshlrev_b32 v88, 16, v34
    v_and_b32 v89, 0xffff0000, v34
    v_add_f32 v84, v84, v88
    v_add_f32 v85, v85, v89
    v_fma_f32 v86, v88, v88, v86
    v_fma_f32 v87, v89, v89, v87
    v_lshlrev_b32 v90, 16, v35
    v_and_b32 v91, 0xffff0000, v35
    v_add_f32 v84, v84, v90
    v_add_f32 v85, v85, v91
    v_fma_f32 v86, v90, v90, v86
    v_fma_f32 v87, v91, v91, v87
    s_waitcnt vmcnt(20)
    s_barrier
    s_waitcnt lgkmcnt(4)
    v_mfma_f32_32x32x16_bf16 v[96:111], v[60:63], v[52:55], v[96:111]
    ds_read_b64_tr_b16 v[32:33], v8 offset:40960
    ds_read_b64_tr_b16 v[34:35], v8 offset:41984
    v_lshlrev_b32 v88, 16, v52
    v_and_b32 v89, 0xffff0000, v52
    s_add_u32 m0, s6, 0
    s_waitcnt lgkmcnt(4)
    v_mfma_f32_32x32x16_bf16 v[144:159], v[60:63], v[56:59], v[144:159]
    buffer_load_dwordx4 v5, s[8:11], s43 offen lds
    ds_read_b128 v[40:43], v10 offset:40960
    s_waitcnt lgkmcnt(4)
    v_mfma_f32_32x32x16_bf16 v[112:127], v[64:67], v[52:55], v[112:127]
    ds_read_b64_tr_b16 v[36:37], v9 offset:40960
    ds_read_b64_tr_b16 v[38:39], v9 offset:41984
    v_add_f32 v84, v84, v88
    v_add_f32 v85, v85, v89
    s_add_u32 m0, s6, 1024
    v_mfma_f32_32x32x16_bf16 v[160:175], v[64:67], v[56:59], v[160:175]
    buffer_load_dwordx4 v6, s[8:11], s43 offen lds
    ds_read_b128 v[44:47], v10 offset:41984
    s_waitcnt lgkmcnt(6)
    v_mfma_f32_32x32x16_bf16 v[128:143], v[68:71], v[52:55], v[128:143]
    ds_read_b128 v[48:51], v10 offset:43008
    v_fma_f32 v86, v88, v88, v86
    v_fma_f32 v87, v89, v89, v87
    v_lshlrev_b32 v90, 16, v53
    v_and_b32 v91, 0xffff0000, v53
    v_mfma_f32_32x32x16_bf16 v[176:191], v[68:71], v[56:59], v[176:191]
    v_add_f32 v84, v84, v90
    v_add_f32 v85, v85, v91
    v_fma_f32 v86, v90, v90, v86
    v_fma_f32 v87, v91, v91, v87
    v_lshlrev_b32 v88, 16, v54
    v_and_b32 v89, 0xffff0000, v54
    v_add_f32 v84, v84, v88
    v_add_f32 v85, v85, v89
    v_fma_f32 v86, v88, v88, v86
    v_fma_f32 v87, v89, v89, v87
    v_lshlrev_b32 v90, 16, v55
    v_and_b32 v91, 0xffff0000, v55
    v_add_f32 v84, v84, v90
    v_add_f32 v85, v85, v91
    v_fma_f32 v86, v90, v90, v86
    v_fma_f32 v87, v91, v91, v87
    s_waitcnt lgkmcnt(4)
    v_mfma_f32_32x32x16_bf16 v[96:111], v[40:43], v[32:35], v[96:111]
    ds_read_b64_tr_b16 v[52:53], v8 offset:45056
    ds_read_b64_tr_b16 v[54:55], v8 offset:46080
    v_add_f32 v84, v84, v85
    v_add_f32 v86, v86, v87
    s_add_u32 m0, s7, 0
    s_waitcnt lgkmcnt(4)
    v_mfma_f32_32x32x16_bf16 v[144:159], v[40:43], v[36:39], v[144:159]
    buffer_load_dwordx4 v7, s[12:15], s63 offen lds
    ds_read_b128 v[60:63], v10 offset:47104
    s_waitcnt lgkmcnt(4)
    v_mfma_f32_32x32x16_bf16 v[112:127], v[44:47], v[32:35], v[112:127]
    ds_read_b64_tr_b16 v[56:57], v9 offset:45056
    ds_read_b64_tr_b16 v[58:59], v9 offset:46080
    v_mov_b32 v88, v84
    v_mov_b32 v89, v86
    s_mul_i32 s80, s20, 10
    v_mfma_f32_32x32x16_bf16 v[160:175], v[44:47], v[36:39], v[160:175]
    buffer_load_dwordx4 v7, s[12:15], s63 offen offset:1024 lds
    ds_read_b128 v[64:67], v10 offset:48128
    s_waitcnt lgkmcnt(6)
    v_mfma_f32_32x32x16_bf16 v[128:143], v[48:51], v[32:35], v[128:143]
    ds_read_b128 v[68:71], v10 offset:49152
    s_add_u32 s80, s80, s21
    s_lshl_b32 s80, s80, 11
    v_permlane32_swap_b32 v84, v88
    v_permlane32_swap_b32 v86, v89
    v_mfma_f32_32x32x16_bf16 v[176:191], v[48:51], v[36:39], v[176:191]
    buffer_load_dwordx4 v7, s[12:15], s63 offen offset:2048 lds
    s_lshl_b32 s81, s25, 9
    s_waitcnt vmcnt(20)
    s_barrier
    s_waitcnt lgkmcnt(4)
    v_mfma_f32_32x32x16_bf16 v[96:111], v[60:63], v[52:55], v[96:111]
    ds_read_b64_tr_b16 v[32:33], v11 offset:0
    ds_read_b64_tr_b16 v[34:35], v11 offset:1024
    s_add_u32 s80, s80, s81
    s_add_u32 s80, s80, 2228224
    s_add_u32 m0, s6, 20480
    s_waitcnt lgkmcnt(4)
    v_mfma_f32_32x32x16_bf16 v[144:159], v[60:63], v[56:59], v[144:159]
    buffer_load_dwordx4 v5, s[8:11], s44 offen lds
    ds_read_b128 v[40:43], v13 offset:0
    s_waitcnt lgkmcnt(4)
    v_mfma_f32_32x32x16_bf16 v[112:127], v[64:67], v[52:55], v[112:127]
    ds_read_b64_tr_b16 v[36:37], v12 offset:0
    ds_read_b64_tr_b16 v[38:39], v12 offset:1024
    v_add_f32 v84, v84, v88
    v_add_f32 v85, v86, v89
    s_add_u32 m0, s6, 21504
    v_mfma_f32_32x32x16_bf16 v[160:175], v[64:67], v[56:59], v[160:175]
    buffer_load_dwordx4 v6, s[8:11], s44 offen lds
    ds_read_b128 v[44:47], v13 offset:1024
    s_waitcnt lgkmcnt(6)
    v_mfma_f32_32x32x16_bf16 v[128:143], v[68:71], v[52:55], v[128:143]
    ds_read_b128 v[48:51], v13 offset:2048
    v_mov_b32 v86, 1
    v_mov_b32 v87, 0
    s_cmp_lt_u32 s21, 10
    s_cselect_b32 s81, 32, 0
    v_mfma_f32_32x32x16_bf16 v[176:191], v[68:71], v[56:59], v[176:191]
    v_lshlrev_b32 v88, 4, v1
    v_cmp_gt_u32 vcc, s81, v1
    s_nop 1
    v_cndmask_b32 v88, v29, v88, vcc
    buffer_store_dwordx4 v[84:87], v88, s[28:31], s80 offen sc0 sc1
    s_waitcnt lgkmcnt(4)
    v_mfma_f32_32x32x16_bf16 v[96:111], v[40:43], v[32:35], v[96:111]
    ds_read_b64_tr_b16 v[52:53], v11 offset:4096
    ds_read_b64_tr_b16 v[54:55], v11 offset:5120
    s_add_u32 s76, s4, 81920
    s_addc_u32 s77, s5, 0
    s_add_u32 m0, s7, 20480
    s_waitcnt lgkmcnt(4)
    v_mfma_f32_32x32x16_bf16 v[144:159], v[40:43], v[36:39], v[144:159]
    buffer_load_dwordx4 v7, s[12:15], s64 offen lds
    ds_read_b128 v[60:63], v13 offset:6144
    s_waitcnt lgkmcnt(4)
    v_mfma_f32_32x32x16_bf16 v[112:127], v[44:47], v[32:35], v[112:127]
    ds_read_b64_tr_b16 v[56:57], v12 offset:4096
    ds_read_b64_tr_b16 v[58:59], v12 offset:5120
    s_mov_b32 s78, 122880
    s_mov_b32 s79, 0x20000
    s_mul_i32 s80, s21, 6*256
    v_mfma_f32_32x32x16_bf16 v[160:175], v[44:47], v[36:39], v[160:175]
    buffer_load_dwordx4 v7, s[12:15], s64 offen offset:1024 lds
    ds_read_b128 v[64:67], v13 offset:7168
    s_waitcnt lgkmcnt(6)
    v_mfma_f32_32x32x16_bf16 v[128:143], v[48:51], v[32:35], v[128:143]
    ds_read_b128 v[68:71], v13 offset:8192
    v_min_u32 v17, 191, v0
    v_lshlrev_b32 v17, 3, v17
    v_add_u32 v17, s80, v17
    s_mov_b32 s80, 0
    v_mfma_f32_32x32x16_bf16 v[176:191], v[48:51], v[36:39], v[176:191]
    buffer_load_dwordx4 v7, s[12:15], s64 offen offset:2048 lds
    buffer_load_dwordx2 v[224:225], v17, s[76:79], s80 offen
    s_waitcnt vmcnt(21)
    s_barrier
    s_waitcnt lgkmcnt(4)
    v_mfma_f32_32x32x16_bf16 v[96:111], v[60:63], v[52:55], v[96:111]
    ds_read_b64_tr_b16 v[32:33], v11 offset:20480
    ds_read_b64_tr_b16 v[34:35], v11 offset:21504
    s_mov_b32 s80, 24576
    buffer_load_dwordx2 v[226:227], v17, s[76:79], s80 offen
    s_add_u32 m0, s6, 40960
    s_waitcnt lgkmcnt(4)
    v_mfma_f32_32x32x16_bf16 v[144:159], v[60:63], v[56:59], v[144:159]
    buffer_load_dwordx4 v5, s[8:11], s45 offen lds
    ds_read_b128 v[40:43], v13 offset:20480
    s_waitcnt lgkmcnt(4)
    v_mfma_f32_32x32x16_bf16 v[112:127], v[64:67], v[52:55], v[112:127]
    ds_read_b64_tr_b16 v[36:37], v12 offset:20480
    ds_read_b64_tr_b16 v[38:39], v12 offset:21504
    s_mov_b32 s80, 49152
    buffer_load_dwordx2 v[228:229], v17, s[76:79], s80 offen
    s_add_u32 m0, s6, 41984
    v_mfma_f32_32x32x16_bf16 v[160:175], v[64:67], v[56:59], v[160:175]
    buffer_load_dwordx4 v6, s[8:11], s45 offen lds
    ds_read_b128 v[44:47], v13 offset:21504
    s_waitcnt lgkmcnt(6)
    v_mfma_f32_32x32x16_bf16 v[128:143], v[68:71], v[52:55], v[128:143]
    ds_read_b128 v[48:51], v13 offset:22528
    s_mov_b32 s80, 73728
    buffer_load_dwordx2 v[230:231], v17, s[76:79], s80 offen
    s_mov_b32 s80, 98304
    v_mfma_f32_32x32x16_bf16 v[176:191], v[68:71], v[56:59], v[176:191]
    buffer_load_dwordx2 v[232:233], v17, s[76:79], s80 offen
    s_add_u32 s76, s4, 0
    s_addc_u32 s77, s5, 0
    s_mov_b32 s78, 61440
    s_waitcnt lgkmcnt(4)
    v_mfma_f32_32x32x16_bf16 v[96:111], v[40:43], v[32:35], v[96:111]
    ds_read_b64_tr_b16 v[52:53], v11 offset:24576
    ds_read_b64_tr_b16 v[54:55], v11 offset:25600
    s_mul_i32 s80, s27, 320
    v_min_u32 v18, 79, v0
    s_add_u32 m0, s7, 40960
    s_waitcnt lgkmcnt(4)
    v_mfma_f32_32x32x16_bf16 v[144:159], v[40:43], v[36:39], v[144:159]
    buffer_load_dwordx4 v7, s[12:15], s65 offen lds
    ds_read_b128 v[60:63], v13 offset:26624
    s_waitcnt lgkmcnt(4)
    v_mfma_f32_32x32x16_bf16 v[112:127], v[44:47], v[32:35], v[112:127]
    ds_read_b64_tr_b16 v[56:57], v12 offset:24576
    ds_read_b64_tr_b16 v[58:59], v12 offset:25600
    v_lshlrev_b32 v18, 2, v18
    v_add_u32 v17, s80, v18
    s_mov_b32 s80, 12800
    v_mfma_f32_32x32x16_bf16 v[160:175], v[44:47], v[36:39], v[160:175]
    buffer_load_dwordx4 v7, s[12:15], s65 offen offset:1024 lds
    ds_read_b128 v[64:67], v13 offset:27648
    s_waitcnt lgkmcnt(6)
    v_mfma_f32_32x32x16_bf16 v[128:143], v[48:51], v[32:35], v[128:143]
    ds_read_b128 v[68:71], v13 offset:28672
    buffer_load_dword v234, v17, s[76:79], s80 offen
    s_mov_b32 s80, 28160
    buffer_load_dword v235, v17, s[76:79], s80 offen
    v_mfma_f32_32x32x16_bf16 v[176:191], v[48:51], v[36:39], v[176:191]
    buffer_load_dwordx4 v7, s[12:15], s65 offen offset:2048 lds
    s_mov_b32 s80, 43520
    s_waitcnt vmcnt(27)
    s_barrier
    s_waitcnt lgkmcnt(4)
    v_mfma_f32_32x32x16_bf16 v[96:111], v[60:63], v[52:55], v[96:111]
    ds_read_b64_tr_b16 v[32:33], v11 offset:40960
    ds_read_b64_tr_b16 v[34:35], v11 offset:41984
    buffer_load_dword v236, v17, s[76:79], s80 offen
    s_add_u32 m0, s6, 61440
    s_waitcnt lgkmcnt(4)
    v_mfma_f32_32x32x16_bf16 v[144:159], v[60:63], v[56:59], v[144:159]
    buffer_load_dwordx4 v5, s[8:11], s46 offen lds
    ds_read_b128 v[40:43], v13 offset:40960
    s_waitcnt lgkmcnt(4)
    v_mfma_f32_32x32x16_bf16 v[112:127], v[64:67], v[52:55], v[112:127]
    ds_read_b64_tr_b16 v[36:37], v12 offset:40960
    ds_read_b64_tr_b16 v[38:39], v12 offset:41984
    s_mov_b32 s80, 58880
    buffer_load_dword v237, v17, s[76:79], s80 offen
    s_add_u32 m0, s6, 62464
    v_mfma_f32_32x32x16_bf16 v[160:175], v[64:67], v[56:59], v[160:175]
    buffer_load_dwordx4 v6, s[8:11], s46 offen lds
    ds_read_b128 v[44:47], v13 offset:41984
    s_waitcnt lgkmcnt(6)
    v_mfma_f32_32x32x16_bf16 v[128:143], v[68:71], v[52:55], v[128:143]
    ds_read_b128 v[48:51], v13 offset:43008
    v_lshrrev_b32 v17, 3, v1
    v_and_b32 v18, 7, v1
    v_lshlrev_b32 v17, 12, v17
    v_lshl_add_u32 v17, v18, 4, v17
    v_mfma_f32_32x32x16_bf16 v[176:191], v[68:71], v[56:59], v[176:191]
    s_mul_i32 s76, s27, 80*4096
    s_lshl_b32 s81, s3, 7
    s_add_u32 s76, s76, s81
    s_lshl_b32 s77, s22, 15
    s_add_u32 s77, s77, s76
    s_lshl_b32 s78, s22, 10
    s_add_u32 s78, s78, 144896
    s_mov_b32 m0, s78
    s_nop 0
    buffer_load_dwordx4 v17, s[8:11], s77 offen lds
    s_add_u32 s77, s77, 131072
    s_add_u32 s78, s78, 4096
    s_mov_b32 m0, s78
    s_nop 0
    buffer_load_dwordx4 v17, s[8:11], s77 offen lds
    s_and_b32 s81, s22, 1
    s_add_u32 s81, s81, 8
    s_lshl_b32 s78, s81, 10
    s_add_u32 s78, s78, 144896
    s_lshl_b32 s81, s81, 15
    s_add_u32 s77, s76, s81
    s_mov_b32 m0, s78
    s_nop 0
    buffer_load_dwordx4 v17, s[8:11], s77 offen lds
    s_waitcnt lgkmcnt(4)
    v_mfma_f32_32x32x16_bf16 v[96:111], v[40:43], v[32:35], v[96:111]
    ds_read_b64_tr_b16 v[52:53], v11 offset:45056
    ds_read_b64_tr_b16 v[54:55], v11 offset:46080
    s_add_u32 m0, s7, 61440
    s_waitcnt lgkmcnt(4)
    v_mfma_f32_32x32x16_bf16 v[144:159], v[40:43], v[36:39], v[144:159]
    buffer_load_dwordx4 v7, s[12:15], s66 offen lds
    ds_read_b128 v[60:63], v13 offset:47104
    s_waitcnt lgkmcnt(4)
    v_mfma_f32_32x32x16_bf16 v[112:127], v[44:47], v[32:35], v[112:127]
    ds_read_b64_tr_b16 v[56:57], v12 offset:45056
    ds_read_b64_tr_b16 v[58:59], v12 offset:46080
    v_mfma_f32_32x32x16_bf16 v[160:175], v[44:47], v[36:39], v[160:175]
    buffer_load_dwordx4 v7, s[12:15], s66 offen offset:1024 lds
    ds_read_b128 v[64:67], v13 offset:48128
    s_waitcnt lgkmcnt(6)
    v_mfma_f32_32x32x16_bf16 v[128:143], v[48:51], v[32:35], v[128:143]
    ds_read_b128 v[68:71], v13 offset:49152
    v_mfma_f32_32x32x16_bf16 v[176:191], v[48:51], v[36:39], v[176:191]
    buffer_load_dwordx4 v7, s[12:15], s66 offen offset:2048 lds
    s_waitcnt vmcnt(32)
    s_barrier
    s_waitcnt lgkmcnt(4)
    v_mfma_f32_32x32x16_bf16 v[96:111], v[60:63], v[52:55], v[96:111]
    ds_read_b64_tr_b16 v[32:33], v14 offset:0
    ds_read_b64_tr_b16 v[34:35], v14 offset:1024
    s_add_u32 m0, s6, 81920
    s_waitcnt lgkmcnt(4)
    v_mfma_f32_32x32x16_bf16 v[144:159], v[60:63], v[56:59], v[144:159]
    buffer_load_dwordx4 v5, s[8:11], s47 offen lds
    ds_read_b128 v[40:43], v16 offset:0
    s_waitcnt lgkmcnt(4)
    v_mfma_f32_32x32x16_bf16 v[112:127], v[64:67], v[52:55], v[112:127]
    ds_read_b64_tr_b16 v[36:37], v15 offset:0
    ds_read_b64_tr_b16 v[38:39], v15 offset:1024
    s_add_u32 m0, s6, 82944
    v_mfma_f32_32x32x16_bf16 v[160:175], v[64:67], v[56:59], v[160:175]
    buffer_load_dwordx4 v6, s[8:11], s47 offen lds
    ds_read_b128 v[44:47], v16 offset:1024
    s_waitcnt lgkmcnt(6)
    v_mfma_f32_32x32x16_bf16 v[128:143], v[68:71], v[52:55], v[128:143]
    ds_read_b128 v[48:51], v16 offset:2048
    v_mfma_f32_32x32x16_bf16 v[176:191], v[68:71], v[56:59], v[176:191]
    s_waitcnt lgkmcnt(4)
    v_mfma_f32_32x32x16_bf16 v[96:111], v[40:43], v[32:35], v[96:111]
    ds_read_b64_tr_b16 v[52:53], v14 offset:4096
    ds_read_b64_tr_b16 v[54:55], v14 offset:5120
    s_add_u32 m0, s7, 81920
    s_waitcnt lgkmcnt(4)
    v_mfma_f32_32x32x16_bf16 v[144:159], v[40:43], v[36:39], v[144:159]
    buffer_load_dwordx4 v7, s[12:15], s67 offen lds
    ds_read_b128 v[60:63], v16 offset:6144
    s_waitcnt lgkmcnt(4)
    v_mfma_f32_32x32x16_bf16 v[112:127], v[44:47], v[32:35], v[112:127]
    ds_read_b64_tr_b16 v[56:57], v15 offset:4096
    ds_read_b64_tr_b16 v[58:59], v15 offset:5120
    v_mfma_f32_32x32x16_bf16 v[160:175], v[44:47], v[36:39], v[160:175]
    buffer_load_dwordx4 v7, s[12:15], s67 offen offset:1024 lds
    ds_read_b128 v[64:67], v16 offset:7168
    s_waitcnt lgkmcnt(6)
    v_mfma_f32_32x32x16_bf16 v[128:143], v[48:51], v[32:35], v[128:143]
    ds_read_b128 v[68:71], v16 offset:8192
    v_mfma_f32_32x32x16_bf16 v[176:191], v[48:51], v[36:39], v[176:191]
    buffer_load_dwordx4 v7, s[12:15], s67 offen offset:2048 lds
    s_waitcnt vmcnt(32)
    s_barrier
    s_waitcnt lgkmcnt(4)
    v_mfma_f32_32x32x16_bf16 v[96:111], v[60:63], v[52:55], v[96:111]
    ds_read_b64_tr_b16 v[32:33], v8 offset:0
    ds_read_b64_tr_b16 v[34:35], v8 offset:1024
    s_add_u32 m0, s6, 102400
    s_waitcnt lgkmcnt(4)
    v_mfma_f32_32x32x16_bf16 v[144:159], v[60:63], v[56:59], v[144:159]
    buffer_load_dwordx4 v5, s[8:11], s48 offen lds
    ds_read_b128 v[40:43], v10 offset:0
    s_waitcnt lgkmcnt(4)
    v_mfma_f32_32x32x16_bf16 v[112:127], v[64:67], v[52:55], v[112:127]
    ds_read_b64_tr_b16 v[36:37], v9 offset:0
    ds_read_b64_tr_b16 v[38:39], v9 offset:1024
    s_add_u32 m0, s6, 103424
    v_mfma_f32_32x32x16_bf16 v[160:175], v[64:67], v[56:59], v[160:175]
    buffer_load_dwordx4 v6, s[8:11], s48 offen lds
    ds_read_b128 v[44:47], v10 offset:1024
    s_waitcnt lgkmcnt(6)
    v_mfma_f32_32x32x16_bf16 v[128:143], v[68:71], v[52:55], v[128:143]
    ds_read_b128 v[48:51], v10 offset:2048
    v_mfma_f32_32x32x16_bf16 v[176:191], v[68:71], v[56:59], v[176:191]
    s_waitcnt lgkmcnt(4)
    v_mfma_f32_32x32x16_bf16 v[96:111], v[40:43], v[32:35], v[96:111]
    ds_read_b64_tr_b16 v[52:53], v8 offset:4096
    ds_read_b64_tr_b16 v[54:55], v8 offset:5120
    s_add_u32 m0, s7, 102400
    s_waitcnt lgkmcnt(4)
    v_mfma_f32_32x32x16_bf16 v[144:159], v[40:43], v[36:39], v[144:159]
    buffer_load_dwordx4 v7, s[12:15], s68 offen lds
    ds_read_b128 v[60:63], v10 offset:6144
    s_waitcnt lgkmcnt(4)
    v_mfma_f32_32x32x16_bf16 v[112:127], v[44:47], v[32:35], v[112:127]
    ds_read_b64_tr_b16 v[56:57], v9 offset:4096
    ds_read_b64_tr_b16 v[58:59], v9 offset:5120
    v_mfma_f32_32x32x16_bf16 v[160:175], v[44:47], v[36:39], v[160:175]
    buffer_load_dwordx4 v7, s[12:15], s68 offen offset:1024 lds
    ds_read_b128 v[64:67], v10 offset:7168
    s_waitcnt lgkmcnt(6)
    v_mfma_f32_32x32x16_bf16 v[128:143], v[48:51], v[32:35], v[128:143]
    ds_read_b128 v[68:71], v10 offset:8192
    v_mfma_f32_32x32x16_bf16 v[176:191], v[48:51], v[36:39], v[176:191]
    buffer_load_dwordx4 v7, s[12:15], s68 offen offset:2048 lds
    s_waitcnt vmcnt(32)
    s_barrier
    s_waitcnt lgkmcnt(4)
    v_mfma_f32_32x32x16_bf16 v[96:111], v[60:63], v[52:55], v[96:111]
    ds_read_b64_tr_b16 v[32:33], v8 offset:20480
    ds_read_b64_tr_b16 v[34:35], v8 offset:21504
    s_add_u32 m0, s6, 122880
    s_waitcnt lgkmcnt(4)
    v_mfma_f32_32x32x16_bf16 v[144:159], v[60:63], v[56:59], v[144:159]
    buffer_load_dwordx4 v5, s[8:11], s49 offen lds
    ds_read_b128 v[40:43], v10 offset:20480
    s_waitcnt lgkmcnt(4)
    v_mfma_f32_32x32x16_bf16 v[112:127], v[64:67], v[52:55], v[112:127]
    ds_read_b64_tr_b16 v[36:37], v9 offset:20480
    ds_read_b64_tr_b16 v[38:39], v9 offset:21504
    s_add_u32 m0, s6, 123904
    v_mfma_f32_32x32x16_bf16 v[160:175], v[64:67], v[56:59], v[160:175]
    buffer_load_dwordx4 v6, s[8:11], s49 offen lds
    ds_read_b128 v[44:47], v10 offset:21504
    s_waitcnt lgkmcnt(6)
    v_mfma_f32_32x32x16_bf16 v[128:143], v[68:71], v[52:55], v[128:143]
    ds_read_b128 v[48:51], v10 offset:22528
    v_mfma_f32_32x32x16_bf16 v[176:191], v[68:71], v[56:59], v[176:191]
    s_waitcnt lgkmcnt(4)
    v_mfma_f32_32x32x16_bf16 v[96:111], v[40:43], v[32:35], v[96:111]
    ds_read_b64_tr_b16 v[52:53], v8 offset:24576
    ds_read_b64_tr_b16 v[54:55], v8 offset:25600
    s_add_u32 m0, s7, 122880
    s_waitcnt lgkmcnt(4)
    v_mfma_f32_32x32x16_bf16 v[144:159], v[40:43], v[36:39], v[144:159]
    buffer_load_dwordx4 v7, s[12:15], s69 offen lds
    ds_read_b128 v[60:63], v10 offset:26624
    s_waitcnt lgkmcnt(4)
    v_mfma_f32_32x32x16_bf16 v[112:127], v[44:47], v[32:35], v[112:127]
    ds_read_b64_tr_b16 v[56:57], v9 offset:24576
    ds_read_b64_tr_b16 v[58:59], v9 offset:25600
    v_mfma_f32_32x32x16_bf16 v[160:175], v[44:47], v[36:39], v[160:175]
    buffer_load_dwordx4 v7, s[12:15], s69 offen offset:1024 lds
    ds_read_b128 v[64:67], v10 offset:27648
    s_waitcnt lgkmcnt(6)
    v_mfma_f32_32x32x16_bf16 v[128:143], v[48:51], v[32:35], v[128:143]
    ds_read_b128 v[68:71], v10 offset:28672
    v_mfma_f32_32x32x16_bf16 v[176:191], v[48:51], v[36:39], v[176:191]
    buffer_load_dwordx4 v7, s[12:15], s69 offen offset:2048 lds
    s_waitcnt vmcnt(25)
    s_barrier
    s_waitcnt lgkmcnt(4)
    v_mfma_f32_32x32x16_bf16 v[96:111], v[60:63], v[52:55], v[96:111]
    ds_read_b64_tr_b16 v[32:33], v8 offset:40960
    ds_read_b64_tr_b16 v[34:35], v8 offset:41984
    s_add_u32 m0, s6, 0
    s_waitcnt lgkmcnt(4)
    v_mfma_f32_32x32x16_bf16 v[144:159], v[60:63], v[56:59], v[144:159]
    buffer_load_dwordx4 v5, s[8:11], s50 offen lds
    ds_read_b128 v[40:43], v10 offset:40960
    s_waitcnt lgkmcnt(4)
    v_mfma_f32_32x32x16_bf16 v[112:127], v[64:67], v[52:55], v[112:127]
    ds_read_b64_tr_b16 v[36:37], v9 offset:40960
    ds_read_b64_tr_b16 v[38:39], v9 offset:41984
    s_add_u32 m0, s6, 1024
    v_mfma_f32_32x32x16_bf16 v[160:175], v[64:67], v[56:59], v[160:175]
    buffer_load_dwordx4 v6, s[8:11], s50 offen lds
    ds_read_b128 v[44:47], v10 offset:41984
    s_waitcnt lgkmcnt(6)
    v_mfma_f32_32x32x16_bf16 v[128:143], v[68:71], v[52:55], v[128:143]
    ds_read_b128 v[48:51], v10 offset:43008
    v_mfma_f32_32x32x16_bf16 v[176:191], v[68:71], v[56:59], v[176:191]
    s_waitcnt lgkmcnt(4)
    v_mfma_f32_32x32x16_bf16 v[96:111], v[40:43], v[32:35], v[96:111]
    ds_read_b64_tr_b16 v[52:53], v8 offset:45056
    ds_read_b64_tr_b16 v[54:55], v8 offset:46080
    s_add_u32 m0, s7, 0
    s_waitcnt lgkmcnt(4)
    v_mfma_f32_32x32x16_bf16 v[144:159], v[40:43], v[36:39], v[144:159]
    buffer_load_dwordx4 v7, s[12:15], s70 offen lds
    ds_read_b128 v[60:63], v10 offset:47104
    s_waitcnt lgkmcnt(4)
    v_mfma_f32_32x32x16_bf16 v[112:127], v[44:47], v[32:35], v[112:127]
    ds_read_b64_tr_b16 v[56:57], v9 offset:45056
    ds_read_b64_tr_b16 v[58:59], v9 offset:46080
    v_mfma_f32_32x32x16_bf16 v[160:175], v[44:47], v[36:39], v[160:175]
    buffer_load_dwordx4 v7, s[12:15], s70 offen offset:1024 lds
    ds_read_b128 v[64:67], v10 offset:48128
    s_waitcnt lgkmcnt(6)
    v_mfma_f32_32x32x16_bf16 v[128:143], v[48:51], v[32:35], v[128:143]
    ds_read_b128 v[68:71], v10 offset:49152
    v_mfma_f32_32x32x16_bf16 v[176:191], v[48:51], v[36:39], v[176:191]
    buffer_load_dwordx4 v7, s[12:15], s70 offen offset:2048 lds
    s_waitcnt vmcnt(20)
    s_barrier
    s_waitcnt lgkmcnt(4)
    v_mfma_f32_32x32x16_bf16 v[96:111], v[60:63], v[52:55], v[96:111]
    ds_read_b64_tr_b16 v[32:33], v11 offset:0
    ds_read_b64_tr_b16 v[34:35], v11 offset:1024
    v_add_f32 v224, v224, v226
    v_add_f32 v225, v225, v227
    s_add_u32 m0, s6, 20480
    s_waitcnt lgkmcnt(4)
    v_mfma_f32_32x32x16_bf16 v[144:159], v[60:63], v[56:59], v[144:159]
    buffer_load_dwordx4 v5, s[8:11], s51 offen lds
    ds_read_b128 v[40:43], v13 offset:0
    s_waitcnt lgkmcnt(4)
    v_mfma_f32_32x32x16_bf16 v[112:127], v[64:67], v[52:55], v[112:127]
    ds_read_b64_tr_b16 v[36:37], v12 offset:0
    ds_read_b64_tr_b16 v[38:39], v12 offset:1024
    v_add_f32 v224, v224, v228
    v_add_f32 v225, v225, v229
    s_add_u32 m0, s6, 21504
    v_mfma_f32_32x32x16_bf16 v[160:175], v[64:67], v[56:59], v[160:175]
    buffer_load_dwordx4 v6, s[8:11], s51 offen lds
    ds_read_b128 v[44:47], v13 offset:1024
    s_waitcnt lgkmcnt(6)
    v_mfma_f32_32x32x16_bf16 v[128:143], v[68:71], v[52:55], v[128:143]
    ds_read_b128 v[48:51], v13 offset:2048
    v_add_f32 v224, v224, v230
    v_add_f32 v225, v225, v231
    v_add_f32 v224, v224, v232
    v_add_f32 v225, v225, v233
    v_mfma_f32_32x32x16_bf16 v[176:191], v[68:71], v[56:59], v[176:191]
    v_add_f32 v234, v234, v235
    v_add_f32 v236, v236, v237
    v_add_f32 v234, v234, v236
    v_cvt_pk_bf16_f32 v234, v234, v234
    v_lshlrev_b32 v234, 16, v234
    s_waitcnt lgkmcnt(4)
    v_mfma_f32_32x32x16_bf16 v[96:111], v[40:43], v[32:35], v[96:111]
    ds_read_b64_tr_b16 v[52:53], v11 offset:4096
    ds_read_b64_tr_b16 v[54:55], v11 offset:5120
    v_lshlrev_b32 v17, 2, v0
    v_add_u32 v18, 155136, v17
    s_add_u32 m0, s7, 20480
    s_waitcnt lgkmcnt(4)
    v_mfma_f32_32x32x16_bf16 v[144:159], v[40:43], v[36:39], v[144:159]
    buffer_load_dwordx4 v7, s[12:15], s71 offen lds
    ds_read_b128 v[60:63], v13 offset:6144
    s_waitcnt lgkmcnt(4)
    v_mfma_f32_32x32x16_bf16 v[112:127], v[44:47], v[32:35], v[112:127]
    ds_read_b64_tr_b16 v[56:57], v12 offset:4096
    ds_read_b64_tr_b16 v[58:59], v12 offset:5120
    v_add_u32 v17, 143360, v17
    v_mov_b32 v19, 155456
    v_cmp_gt_u32 vcc, 192, v0
    v_mfma_f32_32x32x16_bf16 v[160:175], v[44:47], v[36:39], v[160:175]
    buffer_load_dwordx4 v7, s[12:15], s71 offen offset:1024 lds
    ds_read_b128 v[64:67], v13 offset:7168
    s_waitcnt lgkmcnt(6)
    v_mfma_f32_32x32x16_bf16 v[128:143], v[48:51], v[32:35], v[128:143]
    ds_read_b128 v[68:71], v13 offset:8192
    v_cndmask_b32 v17, v19, v17, vcc
    v_cmp_gt_u32 vcc, 80, v0
    s_nop 1
    v_cndmask_b32 v18, v19, v18, vcc
    ds_write_b32 v17, v224
    v_mfma_f32_32x32x16_bf16 v[176:191], v[48:51], v[36:39], v[176:191]
    buffer_load_dwordx4 v7, s[12:15], s71 offen offset:2048 lds
    ds_write_b32 v17, v225 offset:768
    s_waitcnt vmcnt(20)
    s_barrier
    s_waitcnt lgkmcnt(6)
    v_mfma_f32_32x32x16_bf16 v[96:111], v[60:63], v[52:55], v[96:111]
    ds_read_b64_tr_b16 v[32:33], v11 offset:20480
    ds_read_b64_tr_b16 v[34:35], v11 offset:21504
    ds_write_b32 v18, v234
    s_add_u32 m0, s6, 40960
    s_waitcnt lgkmcnt(7)
    v_mfma_f32_32x32x16_bf16 v[144:159], v[60:63], v[56:59], v[144:159]
    buffer_load_dwordx4 v5, s[8:11], s52 offen lds
    ds_read_b128 v[40:43], v13 offset:20480
    s_waitcnt lgkmcnt(7)
    v_mfma_f32_32x32x16_bf16 v[112:127], v[64:67], v[52:55], v[112:127]
    ds_read_b64_tr_b16 v[36:37], v12 offset:20480
    ds_read_b64_tr_b16 v[38:39], v12 offset:21504
    s_add_u32 m0, s6, 41984
    v_mfma_f32_32x32x16_bf16 v[160:175], v[64:67], v[56:59], v[160:175]
    buffer_load_dwordx4 v6, s[8:11], s52 offen lds
    ds_read_b128 v[44:47], v13 offset:21504
    s_waitcnt lgkmcnt(9)
    v_mfma_f32_32x32x16_bf16 v[128:143], v[68:71], v[52:55], v[128:143]
    ds_read_b128 v[48:51], v13 offset:22528
    v_mfma_f32_32x32x16_bf16 v[176:191], v[68:71], v[56:59], v[176:191]
    s_waitcnt lgkmcnt(4)
    v_mfma_f32_32x32x16_bf16 v[96:111], v[40:43], v[32:35], v[96:111]
    ds_read_b64_tr_b16 v[52:53], v11 offset:24576
    ds_read_b64_tr_b16 v[54:55], v11 offset:25600
    s_add_u32 m0, s7, 40960
    s_waitcnt lgkmcnt(4)
    v_mfma_f32_32x32x16_bf16 v[144:159], v[40:43], v[36:39], v[144:159]
    buffer_load_dwordx4 v7, s[12:15], s72 offen lds
    ds_read_b128 v[60:63], v13 offset:26624
    s_waitcnt lgkmcnt(4)
    v_mfma_f32_32x32x16_bf16 v[112:127], v[44:47], v[32:35], v[112:127]
    ds_read_b64_tr_b16 v[56:57], v12 offset:24576
    ds_read_b64_tr_b16 v[58:59], v12 offset:25600
    v_mfma_f32_32x32x16_bf16 v[160:175], v[44:47], v[36:39], v[160:175]
    buffer_load_dwordx4 v7, s[12:15], s72 offen offset:1024 lds
    ds_read_b128 v[64:67], v13 offset:27648
    s_waitcnt lgkmcnt(6)
    v_mfma_f32_32x32x16_bf16 v[128:143], v[48:51], v[32:35], v[128:143]
    ds_read_b128 v[68:71], v13 offset:28672
    v_mfma_f32_32x32x16_bf16 v[176:191], v[48:51], v[36:39], v[176:191]
    buffer_load_dwordx4 v7, s[12:15], s72 offen offset:2048 lds
    s_waitcnt vmcnt(20)
    s_barrier
    s_waitcnt lgkmcnt(4)
    v_mfma_f32_32x32x16_bf16 v[96:111], v[60:63], v[52:55], v[96:111]
    ds_read_b64_tr_b16 v[32:33], v11 offset:40960
    ds_read_b64_tr_b16 v[34:35], v11 offset:41984
    s_add_u32 m0, s6, 61440
    s_waitcnt lgkmcnt(4)
    v_mfma_f32_32x32x16_bf16 v[144:159], v[60:63], v[56:59], v[144:159]
    buffer_load_dwordx4 v5, s[8:11], s53 offen lds
    ds_read_b128 v[40:43], v13 offset:40960
    s_waitcnt lgkmcnt(4)
    v_mfma_f32_32x32x16_bf16 v[112:127], v[64:67], v[52:55], v[112:127]
    ds_read_b64_tr_b16 v[36:37], v12 offset:40960
    ds_read_b64_tr_b16 v[38:39], v12 offset:41984
    s_add_u32 m0, s6, 62464
    v_mfma_f32_32x32x16_bf16 v[160:175], v[64:67], v[56:59], v[160:175]
    buffer_load_dwordx4 v6, s[8:11], s53 offen lds
    ds_read_b128 v[44:47], v13 offset:41984
    s_waitcnt lgkmcnt(6)
    v_mfma_f32_32x32x16_bf16 v[128:143], v[68:71], v[52:55], v[128:143]
    ds_read_b128 v[48:51], v13 offset:43008
    v_mfma_f32_32x32x16_bf16 v[176:191], v[68:71], v[56:59], v[176:191]
    s_waitcnt lgkmcnt(4)
    v_mfma_f32_32x32x16_bf16 v[96:111], v[40:43], v[32:35], v[96:111]
    ds_read_b64_tr_b16 v[52:53], v11 offset:45056
    ds_read_b64_tr_b16 v[54:55], v11 offset:46080
    s_add_u32 m0, s7, 61440
    s_waitcnt lgkmcnt(4)
    v_mfma_f32_32x32x16_bf16 v[144:159], v[40:43], v[36:39], v[144:159]
    buffer_load_dwordx4 v7, s[12:15], s73 offen lds
    ds_read_b128 v[60:63], v13 offset:47104
    s_waitcnt lgkmcnt(4)
    v_mfma_f32_32x32x16_bf16 v[112:127], v[44:47], v[32:35], v[112:127]
    ds_read_b64_tr_b16 v[56:57], v12 offset:45056
    ds_read_b64_tr_b16 v[58:59], v12 offset:46080
    v_mfma_f32_32x32x16_bf16 v[160:175], v[44:47], v[36:39], v[160:175]
    buffer_load_dwordx4 v7, s[12:15], s73 offen offset:1024 lds
    ds_read_b128 v[64:67], v13 offset:48128
    s_waitcnt lgkmcnt(6)
    v_mfma_f32_32x32x16_bf16 v[128:143], v[48:51], v[32:35], v[128:143]
    ds_read_b128 v[68:71], v13 offset:49152
    v_mfma_f32_32x32x16_bf16 v[176:191], v[48:51], v[36:39], v[176:191]
    buffer_load_dwordx4 v7, s[12:15], s73 offen offset:2048 lds
    s_waitcnt vmcnt(20)
    s_barrier
    s_waitcnt lgkmcnt(4)
    v_mfma_f32_32x32x16_bf16 v[96:111], v[60:63], v[52:55], v[96:111]
    ds_read_b64_tr_b16 v[32:33], v14 offset:0
    ds_read_b64_tr_b16 v[34:35], v14 offset:1024
    s_add_u32 m0, s6, 81920
    s_waitcnt lgkmcnt(4)
    v_mfma_f32_32x32x16_bf16 v[144:159], v[60:63], v[56:59], v[144:159]
    buffer_load_dwordx4 v5, s[8:11], s54 offen lds
    ds_read_b128 v[40:43], v16 offset:0
    s_waitcnt lgkmcnt(4)
    v_mfma_f32_32x32x16_bf16 v[112:127], v[64:67], v[52:55], v[112:127]
    ds_read_b64_tr_b16 v[36:37], v15 offset:0
    ds_read_b64_tr_b16 v[38:39], v15 offset:1024
    s_add_u32 m0, s6, 82944
    v_mfma_f32_32x32x16_bf16 v[160:175], v[64:67], v[56:59], v[160:175]
    buffer_load_dwordx4 v6, s[8:11], s54 offen lds
    ds_read_b128 v[44:47], v16 offset:1024
    s_waitcnt lgkmcnt(6)
    v_mfma_f32_32x32x16_bf16 v[128:143], v[68:71], v[52:55], v[128:143]
    ds_read_b128 v[48:51], v16 offset:2048
    v_mfma_f32_32x32x16_bf16 v[176:191], v[68:71], v[56:59], v[176:191]
    s_waitcnt lgkmcnt(4)
    v_mfma_f32_32x32x16_bf16 v[96:111], v[40:43], v[32:35], v[96:111]
    ds_read_b64_tr_b16 v[52:53], v14 offset:4096
    ds_read_b64_tr_b16 v[54:55], v14 offset:5120
    s_add_u32 m0, s7, 81920
    s_waitcnt lgkmcnt(4)
    v_mfma_f32_32x32x16_bf16 v[144:159], v[40:43], v[36:39], v[144:159]
    buffer_load_dwordx4 v7, s[12:15], s74 offen lds
    ds_read_b128 v[60:63], v16 offset:6144
    s_waitcnt lgkmcnt(4)
    v_mfma_f32_32x32x16_bf16 v[112:127], v[44:47], v[32:35], v[112:127]
    ds_read_b64_tr_b16 v[56:57], v15 offset:4096
    ds_read_b64_tr_b16 v[58:59], v15 offset:5120
    v_mfma_f32_32x32x16_bf16 v[160:175], v[44:47], v[36:39], v[160:175]
    buffer_load_dwordx4 v7, s[12:15], s74 offen offset:1024 lds
    ds_read_b128 v[64:67], v16 offset:7168
    s_waitcnt lgkmcnt(6)
    v_mfma_f32_32x32x16_bf16 v[128:143], v[48:51], v[32:35], v[128:143]
    ds_read_b128 v[68:71], v16 offset:8192
    v_mfma_f32_32x32x16_bf16 v[176:191], v[48:51], v[36:39], v[176:191]
    buffer_load_dwordx4 v7, s[12:15], s74 offen offset:2048 lds
    s_waitcnt vmcnt(20)
    s_barrier
    s_waitcnt lgkmcnt(4)
    v_mfma_f32_32x32x16_bf16 v[96:111], v[60:63], v[52:55], v[96:111]
    ds_read_b64_tr_b16 v[32:33], v8 offset:0
    ds_read_b64_tr_b16 v[34:35], v8 offset:1024
    s_add_u32 m0, s6, 102400
    s_waitcnt lgkmcnt(4)
    v_mfma_f32_32x32x16_bf16 v[144:159], v[60:63], v[56:59], v[144:159]
    buffer_load_dwordx4 v5, s[8:11], s55 offen lds
    ds_read_b128 v[40:43], v10 offset:0
    s_waitcnt lgkmcnt(4)
    v_mfma_f32_32x32x16_bf16 v[112:127], v[64:67], v[52:55], v[112:127]
    ds_read_b64_tr_b16 v[36:37], v9 offset:0
    ds_read_b64_tr_b16 v[38:39], v9 offset:1024
    s_add_u32 m0, s6, 103424
    v_mfma_f32_32x32x16_bf16 v[160:175], v[64:67], v[56:59], v[160:175]
    buffer_load_dwordx4 v6, s[8:11], s55 offen lds
    ds_read_b128 v[44:47], v10 offset:1024
    s_waitcnt lgkmcnt(6)
    v_mfma_f32_32x32x16_bf16 v[128:143], v[68:71], v[52:55], v[128:143]
    ds_read_b128 v[48:51], v10 offset:2048
    v_mfma_f32_32x32x16_bf16 v[176:191], v[68:71], v[56:59], v[176:191]
    s_waitcnt lgkmcnt(4)
    v_mfma_f32_32x32x16_bf16 v[96:111], v[40:43], v[32:35], v[96:111]
    ds_read_b64_tr_b16 v[52:53], v8 offset:4096
    ds_read_b64_tr_b16 v[54:55], v8 offset:5120
    v_and_b32 v88, 31, v1
    v_lshlrev_b32 v88, 4, v88
    s_add_u32 m0, s7, 102400
    s_waitcnt lgkmcnt(4)
    v_mfma_f32_32x32x16_bf16 v[144:159], v[40:43], v[36:39], v[144:159]
    buffer_load_dwordx4 v7, s[12:15], s75 offen lds
    ds_read_b128 v[60:63], v10 offset:6144
    s_waitcnt lgkmcnt(4)
    v_mfma_f32_32x32x16_bf16 v[112:127], v[44:47], v[32:35], v[112:127]
    ds_read_b64_tr_b16 v[56:57], v9 offset:4096
    ds_read_b64_tr_b16 v[58:59], v9 offset:5120
    s_lshl_b32 s80, s25, 9
    s_lshl_b32 s81, s26, 9
    v_mov_b32 v89, s80
    v_mfma_f32_32x32x16_bf16 v[160:175], v[44:47], v[36:39], v[160:175]
    buffer_load_dwordx4 v7, s[12:15], s75 offen offset:1024 lds
    ds_read_b128 v[64:67], v10 offset:7168
    s_waitcnt lgkmcnt(6)
    v_mfma_f32_32x32x16_bf16 v[128:143], v[48:51], v[32:35], v[128:143]
    ds_read_b128 v[68:71], v10 offset:8192
    v_mov_b32 v91, s81
    v_cmp_gt_u32 vcc, 32, v1
    s_nop 1
    v_cndmask_b32 v89, v91, v89, vcc
    v_add_u32 v28, v88, v89
    v_mfma_f32_32x32x16_bf16 v[176:191], v[48:51], v[36:39], v[176:191]
    buffer_load_dwordx4 v7, s[12:15], s75 offen offset:2048 lds
    s_mul_i32 s79, s20, 20480
    s_waitcnt vmcnt(20)
    s_barrier
    s_waitcnt lgkmcnt(4)
    v_mfma_f32_32x32x16_bf16 v[96:111], v[60:63], v[52:55], v[96:111]
    ds_read_b64_tr_b16 v[32:33], v8 offset:20480
    ds_read_b64_tr_b16 v[34:35], v8 offset:21504
    s_add_u32 s79, s79, 2228224
    s_mov_b32 s80, s79
    s_add_u32 s85, s84, 0
    s_waitcnt lgkmcnt(4)
    v_mfma_f32_32x32x16_bf16 v[144:159], v[60:63], v[56:59], v[144:159]
    buffer_load_dwordx4 a[0:3], v7, s[32:35], s85 offen offset:0
    ds_read_b128 v[40:43], v10 offset:20480
    s_waitcnt lgkmcnt(4)
    v_mfma_f32_32x32x16_bf16 v[112:127], v[64:67], v[52:55], v[112:127]
    ds_read_b64_tr_b16 v[36:37], v9 offset:20480
    ds_read_b64_tr_b16 v[38:39], v9 offset:21504
    buffer_load_dwordx4 v[192:195], v28, s[28:31], s80 offen offset:0 sc0 sc1
    buffer_load_dwordx4 v[196:199], v28, s[28:31], s80 offen offset:2048 sc0 sc1
    v_mfma_f32_32x32x16_bf16 v[160:175], v[64:67], v[56:59], v[160:175]
    buffer_load_dwordx4 a[4:7], v7, s[32:35], s85 offen offset:1024
    ds_read_b128 v[44:47], v10 offset:21504
    s_waitcnt lgkmcnt(6)
    v_mfma_f32_32x32x16_bf16 v[128:143], v[68:71], v[52:55], v[128:143]
    ds_read_b128 v[48:51], v10 offset:22528
    s_add_u32 s80, s80, 4096
    buffer_load_dwordx4 v[200:203], v28, s[28:31], s80 offen offset:0 sc0 sc1
    buffer_load_dwordx4 v[204:207], v28, s[28:31], s80 offen offset:2048 sc0 sc1
    v_mfma_f32_32x32x16_bf16 v[176:191], v[68:71], v[56:59], v[176:191]
    s_add_u32 s80, s80, 4096
    buffer_load_dwordx4 v[208:211], v28, s[28:31], s80 offen offset:0 sc0 sc1
    buffer_load_dwordx4 v[212:215], v28, s[28:31], s80 offen offset:2048 sc0 sc1
    s_waitcnt lgkmcnt(4)
    v_mfma_f32_32x32x16_bf16 v[96:111], v[40:43], v[32:35], v[96:111]
    ds_read_b64_tr_b16 v[52:53], v8 offset:24576
    ds_read_b64_tr_b16 v[54:55], v8 offset:25600
    s_add_u32 s80, s80, 4096
    buffer_load_dwordx4 v[216:219], v28, s[28:31], s80 offen offset:0 sc0 sc1
    s_waitcnt lgkmcnt(4)
    v_mfma_f32_32x32x16_bf16 v[144:159], v[40:43], v[36:39], v[144:159]
    buffer_load_dwordx4 a[8:11], v7, s[32:35], s85 offen offset:2048
    ds_read_b128 v[60:63], v10 offset:26624
    s_waitcnt lgkmcnt(4)
    v_mfma_f32_32x32x16_bf16 v[112:127], v[44:47], v[32:35], v[112:127]
    ds_read_b64_tr_b16 v[56:57], v9 offset:24576
    ds_read_b64_tr_b16 v[58:59], v9 offset:25600
    buffer_load_dwordx4 v[220:223], v28, s[28:31], s80 offen offset:2048 sc0 sc1
    s_add_u32 s80, s80, 4096
    v_mfma_f32_32x32x16_bf16 v[160:175], v[44:47], v[36:39], v[160:175]
    buffer_load_dwordx4 a[12:15], v7, s[32:35], s85 offen offset:3072
    ds_read_b128 v[64:67], v10 offset:27648
    s_waitcnt lgkmcnt(6)
    v_mfma_f32_32x32x16_bf16 v[128:143], v[48:51], v[32:35], v[128:143]
    ds_read_b128 v[68:71], v10 offset:28672
    buffer_load_dwordx4 v[224:227], v28, s[28:31], s80 offen offset:0 sc0 sc1
    buffer_load_dwordx4 v[228:231], v28, s[28:31], s80 offen offset:2048 sc0 sc1
    s_add_u32 s85, s85, 4096
    v_mfma_f32_32x32x16_bf16 v[176:191], v[48:51], v[36:39], v[176:191]
    buffer_load_dwordx4 a[16:19], v7, s[32:35], s85 offen
    s_add_u32 s80, s80, 4096
    s_waitcnt vmcnt(30)
    s_barrier
    s_waitcnt lgkmcnt(4)
    v_mfma_f32_32x32x16_bf16 v[96:111], v[60:63], v[52:55], v[96:111]
    ds_read_b64_tr_b16 v[32:33], v8 offset:40960
    ds_read_b64_tr_b16 v[34:35], v8 offset:41984
    s_add_u32 s85, s84, 20480
    s_waitcnt lgkmcnt(4)
    v_mfma_f32_32x32x16_bf16 v[144:159], v[60:63], v[56:59], v[144:159]
    buffer_load_dwordx4 a[20:23], v7, s[32:35], s85 offen offset:0
    ds_read_b128 v[40:43], v10 offset:40960
    s_waitcnt lgkmcnt(4)
    v_mfma_f32_32x32x16_bf16 v[112:127], v[64:67], v[52:55], v[112:127]
    ds_read_b64_tr_b16 v[36:37], v9 offset:40960
    ds_read_b64_tr_b16 v[38:39], v9 offset:41984
    v_mfma_f32_32x32x16_bf16 v[160:175], v[64:67], v[56:59], v[160:175]
    buffer_load_dwordx4 a[24:27], v7, s[32:35], s85 offen offset:1024
    ds_read_b128 v[44:47], v10 offset:41984
    s_waitcnt lgkmcnt(6)
    v_mfma_f32_32x32x16_bf16 v[128:143], v[68:71], v[52:55], v[128:143]
    ds_read_b128 v[48:51], v10 offset:43008
    v_mfma_f32_32x32x16_bf16 v[176:191], v[68:71], v[56:59], v[176:191]
    s_waitcnt lgkmcnt(4)
    v_mfma_f32_32x32x16_bf16 v[96:111], v[40:43], v[32:35], v[96:111]
    ds_read_b64_tr_b16 v[52:53], v8 offset:45056
    ds_read_b64_tr_b16 v[54:55], v8 offset:46080
    s_waitcnt lgkmcnt(4)
    v_mfma_f32_32x32x16_bf16 v[144:159], v[40:43], v[36:39], v[144:159]
    buffer_load_dwordx4 a[28:31], v7, s[32:35], s85 offen offset:2048
    ds_read_b128 v[60:63], v10 offset:47104
    s_waitcnt lgkmcnt(4)
    v_mfma_f32_32x32x16_bf16 v[112:127], v[44:47], v[32:35], v[112:127]
    ds_read_b64_tr_b16 v[56:57], v9 offset:45056
    ds_read_b64_tr_b16 v[58:59], v9 offset:46080
    v_mfma_f32_32x32x16_bf16 v[160:175], v[44:47], v[36:39], v[160:175]
    buffer_load_dwordx4 a[32:35], v7, s[32:35], s85 offen offset:3072
    ds_read_b128 v[64:67], v10 offset:48128
    s_waitcnt lgkmcnt(6)
    v_mfma_f32_32x32x16_bf16 v[128:143], v[48:51], v[32:35], v[128:143]
    ds_read_b128 v[68:71], v10 offset:49152
    s_add_u32 s85, s85, 4096
    v_mfma_f32_32x32x16_bf16 v[176:191], v[48:51], v[36:39], v[176:191]
    buffer_load_dwordx4 a[36:39], v7, s[32:35], s85 offen
    s_waitcnt vmcnt(30)
    s_barrier
    s_waitcnt lgkmcnt(4)
    v_mfma_f32_32x32x16_bf16 v[96:111], v[60:63], v[52:55], v[96:111]
    ds_read_b64_tr_b16 v[32:33], v11 offset:0
    ds_read_b64_tr_b16 v[34:35], v11 offset:1024
    s_add_u32 s85, s84, 40960
    s_waitcnt lgkmcnt(4)
    v_mfma_f32_32x32x16_bf16 v[144:159], v[60:63], v[56:59], v[144:159]
    buffer_load_dwordx4 a[40:43], v7, s[32:35], s85 offen offset:0
    ds_read_b128 v[40:43], v13 offset:0
    s_waitcnt lgkmcnt(4)
    v_mfma_f32_32x32x16_bf16 v[112:127], v[64:67], v[52:55], v[112:127]
    ds_read_b64_tr_b16 v[36:37], v12 offset:0
    ds_read_b64_tr_b16 v[38:39], v12 offset:1024
    v_mfma_f32_32x32x16_bf16 v[160:175], v[64:67], v[56:59], v[160:175]
    buffer_load_dwordx4 a[44:47], v7, s[32:35], s85 offen offset:1024
    ds_read_b128 v[44:47], v13 offset:1024
    s_waitcnt lgkmcnt(6)
    v_mfma_f32_32x32x16_bf16 v[128:143], v[68:71], v[52:55], v[128:143]
    ds_read_b128 v[48:51], v13 offset:2048
    v_mfma_f32_32x32x16_bf16 v[176:191], v[68:71], v[56:59], v[176:191]
    s_waitcnt lgkmcnt(4)
    v_mfma_f32_32x32x16_bf16 v[96:111], v[40:43], v[32:35], v[96:111]
    ds_read_b64_tr_b16 v[52:53], v11 offset:4096
    ds_read_b64_tr_b16 v[54:55], v11 offset:5120
    s_waitcnt lgkmcnt(4)
    v_mfma_f32_32x32x16_bf16 v[144:159], v[40:43], v[36:39], v[144:159]
    buffer_load_dwordx4 a[48:51], v7, s[32:35], s85 offen offset:2048
    ds_read_b128 v[60:63], v13 offset:6144
    s_waitcnt lgkmcnt(4)
    v_mfma_f32_32x32x16_bf16 v[112:127], v[44:47], v[32:35], v[112:127]
    ds_read_b64_tr_b16 v[56:57], v12 offset:4096
    ds_read_b64_tr_b16 v[58:59], v12 offset:5120
    v_mfma_f32_32x32x16_bf16 v[160:175], v[44:47], v[36:39], v[160:175]
    buffer_load_dwordx4 a[52:55], v7, s[32:35], s85 offen offset:3072
    ds_read_b128 v[64:67], v13 offset:7168
    s_waitcnt lgkmcnt(6)
    v_mfma_f32_32x32x16_bf16 v[128:143], v[48:51], v[32:35], v[128:143]
    ds_read_b128 v[68:71], v13 offset:8192
    s_add_u32 s85, s85, 4096
    v_mfma_f32_32x32x16_bf16 v[176:191], v[48:51], v[36:39], v[176:191]
    buffer_load_dwordx4 a[56:59], v7, s[32:35], s85 offen
    s_waitcnt vmcnt(30)
    s_barrier
    s_waitcnt lgkmcnt(4)
    v_mfma_f32_32x32x16_bf16 v[96:111], v[60:63], v[52:55], v[96:111]
    ds_read_b64_tr_b16 v[32:33], v11 offset:20480
    ds_read_b64_tr_b16 v[34:35], v11 offset:21504
    s_add_u32 s85, s84, 61440
    s_waitcnt lgkmcnt(4)
    v_mfma_f32_32x32x16_bf16 v[144:159], v[60:63], v[56:59], v[144:159]
    buffer_load_dwordx4 a[60:63], v7, s[32:35], s85 offen offset:0
    ds_read_b128 v[40:43], v13 offset:20480
    s_waitcnt lgkmcnt(4)
    v_mfma_f32_32x32x16_bf16 v[112:127], v[64:67], v[52:55], v[112:127]
    ds_read_b64_tr_b16 v[36:37], v12 offset:20480
    ds_read_b64_tr_b16 v[38:39], v12 offset:21504
    v_mfma_f32_32x32x16_bf16 v[160:175], v[64:67], v[56:59], v[160:175]
    buffer_load_dwordx4 a[64:67], v7, s[32:35], s85 offen offset:1024
    ds_read_b128 v[44:47], v13 offset:21504
    s_waitcnt lgkmcnt(6)
    v_mfma_f32_32x32x16_bf16 v[128:143], v[68:71], v[52:55], v[128:143]
    ds_read_b128 v[48:51], v13 offset:22528
    v_mfma_f32_32x32x16_bf16 v[176:191], v[68:71], v[56:59], v[176:191]
    s_waitcnt vmcnt(13)
    s_mov_b32 s78, 0
L_k5_st_chk0:
    v_and_b32 v88, v194, v198
    v_and_b32 v88, v88, v202
    v_and_b32 v88, v88, v206
    v_and_b32 v88, v88, v210
    v_and_b32 v88, v88, v214
    v_and_b32 v88, v88, v218
    v_and_b32 v88, v88, v222
    v_and_b32 v88, v88, v226
    v_and_b32 v88, v88, v230
    v_cmp_ne_u32 vcc, 1, v88
    s_nop 4
    s_cbranch_vccz L_k5_st_ok0
    s_add_u32 s78, s78, 1
    s_cmp_gt_u32 s78, 400000
    s_cbranch_scc1 L_k5_st_ok0
    s_mov_b32 s80, s79
    buffer_load_dwordx4 v[192:195], v28, s[28:31], s80 offen offset:0 sc0 sc1
    buffer_load_dwordx4 v[196:199], v28, s[28:31], s80 offen offset:2048 sc0 sc1
    s_add_u32 s80, s80, 4096
    buffer_load_dwordx4 v[200:203], v28, s[28:31], s80 offen offset:0 sc0 sc1
    buffer_load_dwordx4 v[204:207], v28, s[28:31], s80 offen offset:2048 sc0 sc1
    s_add_u32 s80, s80, 4096
    buffer_load_dwordx4 v[208:211], v28, s[28:31], s80 offen offset:0 sc0 sc1
    buffer_load_dwordx4 v[212:215], v28, s[28:31], s80 offen offset:2048 sc0 sc1
    s_add_u32 s80, s80, 4096
    buffer_load_dwordx4 v[216:219], v28, s[28:31], s80 offen offset:0 sc0 sc1
    buffer_load_dwordx4 v[220:223], v28, s[28:31], s80 offen offset:2048 sc0 sc1
    s_add_u32 s80, s80, 4096
    buffer_load_dwordx4 v[224:227], v28, s[28:31], s80 offen offset:0 sc0 sc1
    buffer_load_dwordx4 v[228:231], v28, s[28:31], s80 offen offset:2048 sc0 sc1
    s_add_u32 s80, s80, 4096
    s_waitcnt vmcnt(0)
    s_branch L_k5_st_chk0
L_k5_st_ok0:
    s_waitcnt lgkmcnt(4)
    v_mfma_f32_32x32x16_bf16 v[96:111], v[40:43], v[32:35], v[96:111]
    ds_read_b64_tr_b16 v[52:53], v11 offset:24576
    ds_read_b64_tr_b16 v[54:55], v11 offset:25600
    v_add_f32 v192, v192, v196
    v_add_f32 v193, v193, v197
    v_add_f32 v192, v192, v200
    s_waitcnt lgkmcnt(4)
    v_mfma_f32_32x32x16_bf16 v[144:159], v[40:43], v[36:39], v[144:159]
    buffer_load_dwordx4 a[68:71], v7, s[32:35], s85 offen offset:2048
    ds_read_b128 v[60:63], v13 offset:26624
    s_waitcnt lgkmcnt(4)
    v_mfma_f32_32x32x16_bf16 v[112:127], v[44:47], v[32:35], v[112:127]
    ds_read_b64_tr_b16 v[56:57], v12 offset:24576
    ds_read_b64_tr_b16 v[58:59], v12 offset:25600
    v_add_f32 v193, v193, v201
    v_add_f32 v192, v192, v204
    v_add_f32 v193, v193, v205
    v_mfma_f32_32x32x16_bf16 v[160:175], v[44:47], v[36:39], v[160:175]
    buffer_load_dwordx4 a[72:75], v7, s[32:35], s85 offen offset:3072
    ds_read_b128 v[64:67], v13 offset:27648
    s_waitcnt lgkmcnt(6)
    v_mfma_f32_32x32x16_bf16 v[128:143], v[48:51], v[32:35], v[128:143]
    ds_read_b128 v[68:71], v13 offset:28672
    v_add_f32 v192, v192, v208
    v_add_f32 v193, v193, v209
    v_add_f32 v192, v192, v212
    s_add_u32 s85, s85, 4096
    v_mfma_f32_32x32x16_bf16 v[176:191], v[48:51], v[36:39], v[176:191]
    buffer_load_dwordx4 a[76:79], v7, s[32:35], s85 offen
    v_add_f32 v193, v193, v213
    s_barrier
    s_waitcnt lgkmcnt(4)
    v_mfma_f32_32x32x16_bf16 v[96:111], v[60:63], v[52:55], v[96:111]
    ds_read_b64_tr_b16 v[32:33], v11 offset:40960
    ds_read_b64_tr_b16 v[34:35], v11 offset:41984
    v_add_f32 v192, v192, v216
    v_add_f32 v193, v193, v217
    s_add_u32 s85, s84, 81920
    s_waitcnt lgkmcnt(4)
    v_mfma_f32_32x32x16_bf16 v[144:159], v[60:63], v[56:59], v[144:159]
    buffer_load_dwordx4 a[80:83], v7, s[32:35], s85 offen offset:0
    ds_read_b128 v[40:43], v13 offset:40960
    s_waitcnt lgkmcnt(4)
    v_mfma_f32_32x32x16_bf16 v[112:127], v[64:67], v[52:55], v[112:127]
    ds_read_b64_tr_b16 v[36:37], v12 offset:40960
    ds_read_b64_tr_b16 v[38:39], v12 offset:41984
    v_add_f32 v192, v192, v220
    v_add_f32 v193, v193, v221
    v_add_f32 v192, v192, v224
    v_mfma_f32_32x32x16_bf16 v[160:175], v[64:67], v[56:59], v[160:175]
    buffer_load_dwordx4 a[84:87], v7, s[32:35], s85 offen offset:1024
    ds_read_b128 v[44:47], v13 offset:41984
    s_waitcnt lgkmcnt(6)
    v_mfma_f32_32x32x16_bf16 v[128:143], v[68:71], v[52:55], v[128:143]
    ds_read_b128 v[48:51], v13 offset:43008
    v_add_f32 v193, v193, v225
    v_add_f32 v192, v192, v228
    v_add_f32 v193, v193, v229
    v_mul_f32 v88, 0x3acccccd, v192
    v_mfma_f32_32x32x16_bf16 v[176:191], v[68:71], v[56:59], v[176:191]
    v_mul_f32 v89, 0x3acccccd, v193
    v_fma_f32 v89, -v88, v88, v89
    v_max_f32 v89, 0, v89
    v_cvt_pk_bf16_f32 v88, v88, v89
    v_and_b32 v89, 0xffff0000, v88
    s_waitcnt lgkmcnt(4)
    v_mfma_f32_32x32x16_bf16 v[96:111], v[40:43], v[32:35], v[96:111]
    ds_read_b64_tr_b16 v[52:53], v11 offset:45056
    ds_read_b64_tr_b16 v[54:55], v11 offset:46080
    v_lshlrev_b32 v88, 16, v88
    v_add_f32 v89, 0x3727c5ac, v89
    v_cvt_pk_bf16_f32 v89, v89, v89
    s_waitcnt lgkmcnt(4)
    v_mfma_f32_32x32x16_bf16 v[144:159], v[40:43], v[36:39], v[144:159]
    buffer_load_dwordx4 a[88:91], v7, s[32:35], s85 offen offset:2048
    ds_read_b128 v[60:63], v13 offset:47104
    s_waitcnt lgkmcnt(4)
    v_mfma_f32_32x32x16_bf16 v[112:127], v[44:47], v[32:35], v[112:127]
    ds_read_b64_tr_b16 v[56:57], v12 offset:45056
    ds_read_b64_tr_b16 v[58:59], v12 offset:46080
    v_lshlrev_b32 v89, 16, v89
    v_sqrt_f32 v89, v89
    s_lshl_b32 s80, s20, 2
    v_mfma_f32_32x32x16_bf16 v[160:175], v[44:47], v[36:39], v[160:175]
    buffer_load_dwordx4 a[92:95], v7, s[32:35], s85 offen offset:3072
    ds_read_b128 v[64:67], v13 offset:48128
    s_waitcnt lgkmcnt(6)
    v_mfma_f32_32x32x16_bf16 v[128:143], v[48:51], v[32:35], v[128:143]
    ds_read_b128 v[68:71], v13 offset:49152
    s_add_u32 s81, s80, s26
    s_add_u32 s80, s80, s25
    v_cvt_pk_bf16_f32 v89, v89, v89
    s_add_u32 s85, s85, 4096
    v_mfma_f32_32x32x16_bf16 v[176:191], v[48:51], v[36:39], v[176:191]
    buffer_load_dwordx4 a[96:99], v7, s[32:35], s85 offen
    v_lshlrev_b32 v89, 16, v89
    v_rcp_f32 v84, v89
    s_mul_i32 s76, s21, 6
    s_mul_i32 s77, s24, 3
    s_add_u32 s76, s76, s77
    v_mul_f32 v85, v88, v84
    v_sub_f32 v85, 0, v85
    v_mov_b32 v86, v84
    v_mov_b32 v87, v85
    s_mul_i32 s80, s80, 96
    s_add_u32 s80, s80, s76
    s_lshl_b32 s80, s80, 10
    v_permlane32_swap_b32 v84, v86
    v_permlane32_swap_b32 v85, v87
    s_mul_i32 s81, s81, 96
    s_add_u32 s81, s81, s76
    s_lshl_b32 s81, s81, 10
    v_mov_b32 v72, 0xc0135761
    v_mov_b32 v73, 0xc0135761
    v_mov_b32 v74, 0xbdd2d3e8
    v_mov_b32 v75, 0xbdd2d3e8
    v_lshrrev_b32 v27, 5, v1
    v_lshlrev_b32 v27, 4, v27
    s_mul_i32 s77, s24, 384
    s_add_u32 s77, s77, 143360
    v_add_u32 v27, s77, v27
    s_waitcnt lgkmcnt(4)
    v_mfma_f32_32x32x16_bf16 v[96:111], v[60:63], v[52:55], v[96:111]
    s_add_u32 s85, s84, 102400
    s_nop 0
    buffer_load_dwordx4 a[100:103], v7, s[32:35], s85 offen offset:0
    s_waitcnt lgkmcnt(2)
    v_mfma_f32_32x32x16_bf16 v[144:159], v[60:63], v[56:59], v[144:159]
    s_waitcnt lgkmcnt(1)
    v_mfma_f32_32x32x16_bf16 v[112:127], v[64:67], v[52:55], v[112:127]
    buffer_load_dwordx4 a[104:107], v7, s[32:35], s85 offen offset:1024
    v_mfma_f32_32x32x16_bf16 v[160:175], v[64:67], v[56:59], v[160:175]
    s_waitcnt lgkmcnt(0)
    v_mfma_f32_32x32x16_bf16 v[128:143], v[68:71], v[52:55], v[128:143]
    buffer_load_dwordx4 a[108:111], v7, s[32:35], s85 offen offset:2048
    v_mfma_f32_32x32x16_bf16 v[176:191], v[68:71], v[56:59], v[176:191]
    ds_read_b128 v[40:43], v27 offset:0
    ds_read_b128 v[56:59], v27 offset:768
    ds_read_b128 v[44:47], v27 offset:32
    ds_read_b128 v[60:63], v27 offset:800
    ds_read_b128 v[48:51], v27 offset:64
    ds_read_b128 v[64:67], v27 offset:832
    ds_read_b128 v[52:55], v27 offset:96
    ds_read_b128 v[68:71], v27 offset:864
    s_waitcnt lgkmcnt(0)
    ds_read_b128 v[212:215], v27 offset:128
    ds_read_b128 v[228:231], v27 offset:896
    ds_read_b128 v[216:219], v27 offset:160
    ds_read_b128 v[232:235], v27 offset:928
    ds_read_b128 v[220:223], v27 offset:192
    ds_read_b128 v[236:239], v27 offset:960
    ds_read_b128 v[224:227], v27 offset:224
    ds_read_b128 v[240:243], v27 offset:992
    v_pk_fma_f32 v[192:193], v[40:41], v[84:85], v[56:57] op_sel:[0,1,0] op_sel_hi:[1,1,1]
    v_pk_fma_f32 v[194:195], v[44:45], v[84:85], v[60:61] op_sel:[0,1,0] op_sel_hi:[1,1,1]
    v_pk_fma_f32 v[200:201], v[42:43], v[84:85], v[58:59] op_sel:[0,1,0] op_sel_hi:[1,1,1]
    v_pk_fma_f32 v[202:203], v[46:47], v[84:85], v[62:63] op_sel:[0,1,0] op_sel_hi:[1,1,1]
    v_pk_fma_f32 v[192:193], v[96:97], v[84:85], v[192:193] op_sel:[0,0,0] op_sel_hi:[1,0,1]
    v_pk_fma_f32 v[194:195], v[100:101], v[84:85], v[194:195] op_sel:[0,0,0] op_sel_hi:[1,0,1]
    v_pk_fma_f32 v[200:201], v[98:99], v[84:85], v[200:201] op_sel:[0,0,0] op_sel_hi:[1,0,1]
    v_pk_fma_f32 v[202:203], v[102:103], v[84:85], v[202:203] op_sel:[0,0,0] op_sel_hi:[1,0,1]
    buffer_load_dwordx4 a[112:115], v7, s[32:35], s85 offen offset:3072
    v_pk_mul_f32 v[196:197], v[192:193], v[192:193]
    v_pk_mul_f32 v[204:205], v[200:201], v[200:201]
    v_pk_fma_f32 v[196:197], v[196:197], v[74:75], v[72:73]
    v_pk_fma_f32 v[204:205], v[204:205], v[74:75], v[72:73]
    v_pk_mul_f32 v[196:197], v[196:197], v[192:193]
    v_pk_mul_f32 v[204:205], v[204:205], v[200:201]
    v_exp_f32 v196, v196
    v_exp_f32 v197, v197
    v_exp_f32 v204, v204
    v_exp_f32 v205, v205
    v_pk_mul_f32 v[194:195], v[194:195], v[192:193]
    v_pk_mul_f32 v[202:203], v[202:203], v[200:201]
    v_pk_add_f32 v[196:197], v[196:197], 1.0 op_sel_hi:[1,0]
    v_pk_add_f32 v[204:205], v[204:205], 1.0 op_sel_hi:[1,0]
    v_rcp_f32 v196, v196
    v_rcp_f32 v197, v197
    v_rcp_f32 v204, v204
    v_rcp_f32 v205, v205
    v_pk_mul_f32 v[194:195], v[194:195], v[196:197]
    v_pk_mul_f32 v[202:203], v[202:203], v[204:205]
    v_cvt_pk_bf16_f32 v76, v194, v195
    v_cvt_pk_bf16_f32 v77, v202, v203
    v_pk_fma_f32 v[192:193], v[48:49], v[84:85], v[64:65] op_sel:[0,1,0] op_sel_hi:[1,1,1]
    v_pk_fma_f32 v[194:195], v[52:53], v[84:85], v[68:69] op_sel:[0,1,0] op_sel_hi:[1,1,1]
    v_pk_fma_f32 v[200:201], v[50:51], v[84:85], v[66:67] op_sel:[0,1,0] op_sel_hi:[1,1,1]
    v_pk_fma_f32 v[202:203], v[54:55], v[84:85], v[70:71] op_sel:[0,1,0] op_sel_hi:[1,1,1]
    v_pk_fma_f32 v[192:193], v[104:105], v[84:85], v[192:193] op_sel:[0,0,0] op_sel_hi:[1,0,1]
    v_pk_fma_f32 v[194:195], v[108:109], v[84:85], v[194:195] op_sel:[0,0,0] op_sel_hi:[1,0,1]
    v_pk_fma_f32 v[200:201], v[106:107], v[84:85], v[200:201] op_sel:[0,0,0] op_sel_hi:[1,0,1]
    v_pk_fma_f32 v[202:203], v[110:111], v[84:85], v[202:203] op_sel:[0,0,0] op_sel_hi:[1,0,1]
    s_add_u32 s85, s85, 4096
    buffer_load_dwordx4 a[116:119], v7, s[32:35], s85 offen
    v_pk_mul_f32 v[196:197], v[192:193], v[192:193]
    v_pk_mul_f32 v[204:205], v[200:201], v[200:201]
    v_pk_fma_f32 v[196:197], v[196:197], v[74:75], v[72:73]
    v_pk_fma_f32 v[204:205], v[204:205], v[74:75], v[72:73]
    v_pk_mul_f32 v[196:197], v[196:197], v[192:193]
    v_pk_mul_f32 v[204:205], v[204:205], v[200:201]
    v_exp_f32 v196, v196
    v_exp_f32 v197, v197
    v_exp_f32 v204, v204
    v_exp_f32 v205, v205
    v_pk_mul_f32 v[194:195], v[194:195], v[192:193]
    v_pk_mul_f32 v[202:203], v[202:203], v[200:201]
    v_pk_add_f32 v[196:197], v[196:197], 1.0 op_sel_hi:[1,0]
    v_pk_add_f32 v[204:205], v[204:205], 1.0 op_sel_hi:[1,0]
    v_rcp_f32 v196, v196
    v_rcp_f32 v197, v197
    v_rcp_f32 v204, v204
    v_rcp_f32 v205, v205
    v_pk_mul_f32 v[194:195], v[194:195], v[196:197]
    v_pk_mul_f32 v[202:203], v[202:203], v[204:205]
    v_cvt_pk_bf16_f32 v78, v194, v195
    v_cvt_pk_bf16_f32 v79, v202, v203
    buffer_store_dwordx4 v[76:79], v7, s[16:19], s80 offen offset:0 sc0 sc1
    v_pk_fma_f32 v[192:193], v[40:41], v[86:87], v[56:57] op_sel:[0,1,0] op_sel_hi:[1,1,1]
    v_pk_fma_f32 v[194:195], v[44:45], v[86:87], v[60:61] op_sel:[0,1,0] op_sel_hi:[1,1,1]
    v_pk_fma_f32 v[200:201], v[42:43], v[86:87], v[58:59] op_sel:[0,1,0] op_sel_hi:[1,1,1]
    v_pk_fma_f32 v[202:203], v[46:47], v[86:87], v[62:63] op_sel:[0,1,0] op_sel_hi:[1,1,1]
    v_pk_fma_f32 v[192:193], v[144:145], v[86:87], v[192:193] op_sel:[0,0,0] op_sel_hi:[1,0,1]
    v_pk_fma_f32 v[194:195], v[148:149], v[86:87], v[194:195] op_sel:[0,0,0] op_sel_hi:[1,0,1]
    v_pk_fma_f32 v[200:201], v[146:147], v[86:87], v[200:201] op_sel:[0,0,0] op_sel_hi:[1,0,1]
    v_pk_fma_f32 v[202:203], v[150:151], v[86:87], v[202:203] op_sel:[0,0,0] op_sel_hi:[1,0,1]
    s_add_u32 s85, s84, 122880
    buffer_load_dwordx4 a[120:123], v7, s[32:35], s85 offen offset:0
    v_pk_mul_f32 v[196:197], v[192:193], v[192:193]
    v_pk_mul_f32 v[204:205], v[200:201], v[200:201]
    v_pk_fma_f32 v[196:197], v[196:197], v[74:75], v[72:73]
    v_pk_fma_f32 v[204:205], v[204:205], v[74:75], v[72:73]
    v_pk_mul_f32 v[196:197], v[196:197], v[192:193]
    v_pk_mul_f32 v[204:205], v[204:205], v[200:201]
    v_exp_f32 v196, v196
    v_exp_f32 v197, v197
    v_exp_f32 v204, v204
    v_exp_f32 v205, v205
    v_pk_mul_f32 v[194:195], v[194:195], v[192:193]
    v_pk_mul_f32 v[202:203], v[202:203], v[200:201]
    v_pk_add_f32 v[196:197], v[196:197], 1.0 op_sel_hi:[1,0]
    v_pk_add_f32 v[204:205], v[204:205], 1.0 op_sel_hi:[1,0]
    v_rcp_f32 v196, v196
    v_rcp_f32 v197, v197
    v_rcp_f32 v204, v204
    v_rcp_f32 v205, v205
    v_pk_mul_f32 v[194:195], v[194:195], v[196:197]
    v_pk_mul_f32 v[202:203], v[202:203], v[204:205]
    v_cvt_pk_bf16_f32 v80, v194, v195
    v_cvt_pk_bf16_f32 v81, v202, v203
    v_pk_fma_f32 v[192:193], v[48:49], v[86:87], v[64:65] op_sel:[0,1,0] op_sel_hi:[1,1,1]
    v_pk_fma_f32 v[194:195], v[52:53], v[86:87], v[68:69] op_sel:[0,1,0] op_sel_hi:[1,1,1]
    v_pk_fma_f32 v[200:201], v[50:51], v[86:87], v[66:67] op_sel:[0,1,0] op_sel_hi:[1,1,1]
    v_pk_fma_f32 v[202:203], v[54:55], v[86:87], v[70:71] op_sel:[0,1,0] op_sel_hi:[1,1,1]
    v_pk_fma_f32 v[192:193], v[152:153], v[86:87], v[192:193] op_sel:[0,0,0] op_sel_hi:[1,0,1]
    v_pk_fma_f32 v[194:195], v[156:157], v[86:87], v[194:195] op_sel:[0,0,0] op_sel_hi:[1,0,1]
    v_pk_fma_f32 v[200:201], v[154:155], v[86:87], v[200:201] op_sel:[0,0,0] op_sel_hi:[1,0,1]
    v_pk_fma_f32 v[202:203], v[158:159], v[86:87], v[202:203] op_sel:[0,0,0] op_sel_hi:[1,0,1]
    buffer_load_dwordx4 a[124:127], v7, s[32:35], s85 offen offset:1024
    v_pk_mul_f32 v[196:197], v[192:193], v[192:193]
    v_pk_mul_f32 v[204:205], v[200:201], v[200:201]
    v_pk_fma_f32 v[196:197], v[196:197], v[74:75], v[72:73]
    v_pk_fma_f32 v[204:205], v[204:205], v[74:75], v[72:73]
    v_pk_mul_f32 v[196:197], v[196:197], v[192:193]
    v_pk_mul_f32 v[204:205], v[204:205], v[200:201]
    v_exp_f32 v196, v196
    v_exp_f32 v197, v197
    v_exp_f32 v204, v204
    v_exp_f32 v205, v205
    v_pk_mul_f32 v[194:195], v[194:195], v[192:193]
    v_pk_mul_f32 v[202:203], v[202:203], v[200:201]
    v_pk_add_f32 v[196:197], v[196:197], 1.0 op_sel_hi:[1,0]
    v_pk_add_f32 v[204:205], v[204:205], 1.0 op_sel_hi:[1,0]
    v_rcp_f32 v196, v196
    v_rcp_f32 v197, v197
    v_rcp_f32 v204, v204
    v_rcp_f32 v205, v205
    v_pk_mul_f32 v[194:195], v[194:195], v[196:197]
    v_pk_mul_f32 v[202:203], v[202:203], v[204:205]
    v_cvt_pk_bf16_f32 v82, v194, v195
    v_cvt_pk_bf16_f32 v83, v202, v203
    buffer_store_dwordx4 v[80:83], v7, s[16:19], s81 offen offset:0 sc0 sc1
    s_waitcnt lgkmcnt(0)
    ds_read_b128 v[40:43], v27 offset:256
    ds_read_b128 v[56:59], v27 offset:1024
    ds_read_b128 v[44:47], v27 offset:288
    ds_read_b128 v[60:63], v27 offset:1056
    ds_read_b128 v[48:51], v27 offset:320
    ds_read_b128 v[64:67], v27 offset:1088
    ds_read_b128 v[52:55], v27 offset:352
    ds_read_b128 v[68:71], v27 offset:1120
    v_pk_fma_f32 v[192:193], v[212:213], v[84:85], v[228:229] op_sel:[0,1,0] op_sel_hi:[1,1,1]
    v_pk_fma_f32 v[194:195], v[216:217], v[84:85], v[232:233] op_sel:[0,1,0] op_sel_hi:[1,1,1]
    v_pk_fma_f32 v[200:201], v[214:215], v[84:85], v[230:231] op_sel:[0,1,0] op_sel_hi:[1,1,1]
    v_pk_fma_f32 v[202:203], v[218:219], v[84:85], v[234:235] op_sel:[0,1,0] op_sel_hi:[1,1,1]
    v_pk_fma_f32 v[192:193], v[112:113], v[84:85], v[192:193] op_sel:[0,0,0] op_sel_hi:[1,0,1]
    v_pk_fma_f32 v[194:195], v[116:117], v[84:85], v[194:195] op_sel:[0,0,0] op_sel_hi:[1,0,1]
    v_pk_fma_f32 v[200:201], v[114:115], v[84:85], v[200:201] op_sel:[0,0,0] op_sel_hi:[1,0,1]
    v_pk_fma_f32 v[202:203], v[118:119], v[84:85], v[202:203] op_sel:[0,0,0] op_sel_hi:[1,0,1]
    buffer_load_dwordx4 a[128:131], v7, s[32:35], s85 offen offset:2048
    v_pk_mul_f32 v[196:197], v[192:193], v[192:193]
    v_pk_mul_f32 v[204:205], v[200:201], v[200:201]
    v_pk_fma_f32 v[196:197], v[196:197], v[74:75], v[72:73]
    v_pk_fma_f32 v[204:205], v[204:205], v[74:75], v[72:73]
    v_pk_mul_f32 v[196:197], v[196:197], v[192:193]
    v_pk_mul_f32 v[204:205], v[204:205], v[200:201]
    v_exp_f32 v196, v196
    v_exp_f32 v197, v197
    v_exp_f32 v204, v204
    v_exp_f32 v205, v205
    v_pk_mul_f32 v[194:195], v[194:195], v[192:193]
    v_pk_mul_f32 v[202:203], v[202:203], v[200:201]
    v_pk_add_f32 v[196:197], v[196:197], 1.0 op_sel_hi:[1,0]
    v_pk_add_f32 v[204:205], v[204:205], 1.0 op_sel_hi:[1,0]
    v_rcp_f32 v196, v196
    v_rcp_f32 v197, v197
    v_rcp_f32 v204, v204
    v_rcp_f32 v205, v205
    v_pk_mul_f32 v[194:195], v[194:195], v[196:197]
    v_pk_mul_f32 v[202:203], v[202:203], v[204:205]
    v_cvt_pk_bf16_f32 v76, v194, v195
    v_cvt_pk_bf16_f32 v77, v202, v203
    v_pk_fma_f32 v[192:193], v[220:221], v[84:85], v[236:237] op_sel:[0,1,0] op_sel_hi:[1,1,1]
    v_pk_fma_f32 v[194:195], v[224:225], v[84:85], v[240:241] op_sel:[0,1,0] op_sel_hi:[1,1,1]
    v_pk_fma_f32 v[200:201], v[222:223], v[84:85], v[238:239] op_sel:[0,1,0] op_sel_hi:[1,1,1]
    v_pk_fma_f32 v[202:203], v[226:227], v[84:85], v[242:243] op_sel:[0,1,0] op_sel_hi:[1,1,1]
    v_pk_fma_f32 v[192:193], v[120:121], v[84:85], v[192:193] op_sel:[0,0,0] op_sel_hi:[1,0,1]
    v_pk_fma_f32 v[194:195], v[124:125], v[84:85], v[194:195] op_sel:[0,0,0] op_sel_hi:[1,0,1]
    v_pk_fma_f32 v[200:201], v[122:123], v[84:85], v[200:201] op_sel:[0,0,0] op_sel_hi:[1,0,1]
    v_pk_fma_f32 v[202:203], v[126:127], v[84:85], v[202:203] op_sel:[0,0,0] op_sel_hi:[1,0,1]
    buffer_load_dwordx4 a[132:135], v7, s[32:35], s85 offen offset:3072
    v_pk_mul_f32 v[196:197], v[192:193], v[192:193]
    v_pk_mul_f32 v[204:205], v[200:201], v[200:201]
    v_pk_fma_f32 v[196:197], v[196:197], v[74:75], v[72:73]
    v_pk_fma_f32 v[204:205], v[204:205], v[74:75], v[72:73]
    v_pk_mul_f32 v[196:197], v[196:197], v[192:193]
    v_pk_mul_f32 v[204:205], v[204:205], v[200:201]
    v_exp_f32 v196, v196
    v_exp_f32 v197, v197
    v_exp_f32 v204, v204
    v_exp_f32 v205, v205
    v_pk_mul_f32 v[194:195], v[194:195], v[192:193]
    v_pk_mul_f32 v[202:203], v[202:203], v[200:201]
    v_pk_add_f32 v[196:197], v[196:197], 1.0 op_sel_hi:[1,0]
    v_pk_add_f32 v[204:205], v[204:205], 1.0 op_sel_hi:[1,0]
    v_rcp_f32 v196, v196
    v_rcp_f32 v197, v197
    v_rcp_f32 v204, v204
    v_rcp_f32 v205, v205
    v_pk_mul_f32 v[194:195], v[194:195], v[196:197]
    v_pk_mul_f32 v[202:203], v[202:203], v[204:205]
    v_cvt_pk_bf16_f32 v78, v194, v195
    v_cvt_pk_bf16_f32 v79, v202, v203
    buffer_store_dwordx4 v[76:79], v7, s[16:19], s80 offen offset:1024 sc0 sc1
    v_pk_fma_f32 v[192:193], v[212:213], v[86:87], v[228:229] op_sel:[0,1,0] op_sel_hi:[1,1,1]
    v_pk_fma_f32 v[194:195], v[216:217], v[86:87], v[232:233] op_sel:[0,1,0] op_sel_hi:[1,1,1]
    v_pk_fma_f32 v[200:201], v[214:215], v[86:87], v[230:231] op_sel:[0,1,0] op_sel_hi:[1,1,1]
    v_pk_fma_f32 v[202:203], v[218:219], v[86:87], v[234:235] op_sel:[0,1,0] op_sel_hi:[1,1,1]
    v_pk_fma_f32 v[192:193], v[160:161], v[86:87], v[192:193] op_sel:[0,0,0] op_sel_hi:[1,0,1]
    v_pk_fma_f32 v[194:195], v[164:165], v[86:87], v[194:195] op_sel:[0,0,0] op_sel_hi:[1,0,1]
    v_pk_fma_f32 v[200:201], v[162:163], v[86:87], v[200:201] op_sel:[0,0,0] op_sel_hi:[1,0,1]
    v_pk_fma_f32 v[202:203], v[166:167], v[86:87], v[202:203] op_sel:[0,0,0] op_sel_hi:[1,0,1]
    s_add_u32 s85, s85, 4096
    buffer_load_dwordx4 a[136:139], v7, s[32:35], s85 offen
    v_pk_mul_f32 v[196:197], v[192:193], v[192:193]
    v_pk_mul_f32 v[204:205], v[200:201], v[200:201]
    v_pk_fma_f32 v[196:197], v[196:197], v[74:75], v[72:73]
    v_pk_fma_f32 v[204:205], v[204:205], v[74:75], v[72:73]
    v_pk_mul_f32 v[196:197], v[196:197], v[192:193]
    v_pk_mul_f32 v[204:205], v[204:205], v[200:201]
    v_exp_f32 v196, v196
    v_exp_f32 v197, v197
    v_exp_f32 v204, v204
    v_exp_f32 v205, v205
    v_pk_mul_f32 v[194:195], v[194:195], v[192:193]
    v_pk_mul_f32 v[202:203], v[202:203], v[200:201]
    v_pk_add_f32 v[196:197], v[196:197], 1.0 op_sel_hi:[1,0]
    v_pk_add_f32 v[204:205], v[204:205], 1.0 op_sel_hi:[1,0]
    v_rcp_f32 v196, v196
    v_rcp_f32 v197, v197
    v_rcp_f32 v204, v204
    v_rcp_f32 v205, v205
    v_pk_mul_f32 v[194:195], v[194:195], v[196:197]
    v_pk_mul_f32 v[202:203], v[202:203], v[204:205]
    v_cvt_pk_bf16_f32 v80, v194, v195
    v_cvt_pk_bf16_f32 v81, v202, v203
    v_pk_fma_f32 v[192:193], v[220:221], v[86:87], v[236:237] op_sel:[0,1,0] op_sel_hi:[1,1,1]
    v_pk_fma_f32 v[194:195], v[224:225], v[86:87], v[240:241] op_sel:[0,1,0] op_sel_hi:[1,1,1]
    v_pk_fma_f32 v[200:201], v[222:223], v[86:87], v[238:239] op_sel:[0,1,0] op_sel_hi:[1,1,1]
    v_pk_fma_f32 v[202:203], v[226:227], v[86:87], v[242:243] op_sel:[0,1,0] op_sel_hi:[1,1,1]
    v_pk_fma_f32 v[192:193], v[168:169], v[86:87], v[192:193] op_sel:[0,0,0] op_sel_hi:[1,0,1]
    v_pk_fma_f32 v[194:195], v[172:173], v[86:87], v[194:195] op_sel:[0,0,0] op_sel_hi:[1,0,1]
    v_pk_fma_f32 v[200:201], v[170:171], v[86:87], v[200:201] op_sel:[0,0,0] op_sel_hi:[1,0,1]
    v_pk_fma_f32 v[202:203], v[174:175], v[86:87], v[202:203] op_sel:[0,0,0] op_sel_hi:[1,0,1]
    s_add_u32 s85, s84, 143360
    buffer_load_dwordx4 a[140:143], v7, s[32:35], s85 offen offset:0
    v_pk_mul_f32 v[196:197], v[192:193], v[192:193]
    v_pk_mul_f32 v[204:205], v[200:201], v[200:201]
    v_pk_fma_f32 v[196:197], v[196:197], v[74:75], v[72:73]
    v_pk_fma_f32 v[204:205], v[204:205], v[74:75], v[72:73]
    v_pk_mul_f32 v[196:197], v[196:197], v[192:193]
    v_pk_mul_f32 v[204:205], v[204:205], v[200:201]
    v_exp_f32 v196, v196
    v_exp_f32 v197, v197
    v_exp_f32 v204, v204
    v_exp_f32 v205, v205
    v_pk_mul_f32 v[194:195], v[194:195], v[192:193]
    v_pk_mul_f32 v[202:203], v[202:203], v[200:201]
    v_pk_add_f32 v[196:197], v[196:197], 1.0 op_sel_hi:[1,0]
    v_pk_add_f32 v[204:205], v[204:205], 1.0 op_sel_hi:[1,0]
    v_rcp_f32 v196, v196
    v_rcp_f32 v197, v197
    v_rcp_f32 v204, v204
    v_rcp_f32 v205, v205
    v_pk_mul_f32 v[194:195], v[194:195], v[196:197]
    v_pk_mul_f32 v[202:203], v[202:203], v[204:205]
    v_cvt_pk_bf16_f32 v82, v194, v195
    v_cvt_pk_bf16_f32 v83, v202, v203
    buffer_store_dwordx4 v[80:83], v7, s[16:19], s81 offen offset:1024 sc0 sc1
    s_waitcnt lgkmcnt(0)
    v_pk_fma_f32 v[192:193], v[40:41], v[84:85], v[56:57] op_sel:[0,1,0] op_sel_hi:[1,1,1]
    v_pk_fma_f32 v[194:195], v[44:45], v[84:85], v[60:61] op_sel:[0,1,0] op_sel_hi:[1,1,1]
    v_pk_fma_f32 v[200:201], v[42:43], v[84:85], v[58:59] op_sel:[0,1,0] op_sel_hi:[1,1,1]
    v_pk_fma_f32 v[202:203], v[46:47], v[84:85], v[62:63] op_sel:[0,1,0] op_sel_hi:[1,1,1]
    v_pk_fma_f32 v[192:193], v[128:129], v[84:85], v[192:193] op_sel:[0,0,0] op_sel_hi:[1,0,1]
    v_pk_fma_f32 v[194:195], v[132:133], v[84:85], v[194:195] op_sel:[0,0,0] op_sel_hi:[1,0,1]
    v_pk_fma_f32 v[200:201], v[130:131], v[84:85], v[200:201] op_sel:[0,0,0] op_sel_hi:[1,0,1]
    v_pk_fma_f32 v[202:203], v[134:135], v[84:85], v[202:203] op_sel:[0,0,0] op_sel_hi:[1,0,1]
    buffer_load_dwordx4 a[144:147], v7, s[32:35], s85 offen offset:1024
    v_pk_mul_f32 v[196:197], v[192:193], v[192:193]
    v_pk_mul_f32 v[204:205], v[200:201], v[200:201]
    v_pk_fma_f32 v[196:197], v[196:197], v[74:75], v[72:73]
    v_pk_fma_f32 v[204:205], v[204:205], v[74:75], v[72:73]
    v_pk_mul_f32 v[196:197], v[196:197], v[192:193]
    v_pk_mul_f32 v[204:205], v[204:205], v[200:201]
    v_exp_f32 v196, v196
    v_exp_f32 v197, v197
    v_exp_f32 v204, v204
    v_exp_f32 v205, v205
    v_pk_mul_f32 v[194:195], v[194:195], v[192:193]
    v_pk_mul_f32 v[202:203], v[202:203], v[200:201]
    v_pk_add_f32 v[196:197], v[196:197], 1.0 op_sel_hi:[1,0]
    v_pk_add_f32 v[204:205], v[204:205], 1.0 op_sel_hi:[1,0]
    v_rcp_f32 v196, v196
    v_rcp_f32 v197, v197
    v_rcp_f32 v204, v204
    v_rcp_f32 v205, v205
    v_pk_mul_f32 v[194:195], v[194:195], v[196:197]
    v_pk_mul_f32 v[202:203], v[202:203], v[204:205]
    v_cvt_pk_bf16_f32 v76, v194, v195
    v_cvt_pk_bf16_f32 v77, v202, v203
    v_pk_fma_f32 v[192:193], v[48:49], v[84:85], v[64:65] op_sel:[0,1,0] op_sel_hi:[1,1,1]
    v_pk_fma_f32 v[194:195], v[52:53], v[84:85], v[68:69] op_sel:[0,1,0] op_sel_hi:[1,1,1]
    v_pk_fma_f32 v[200:201], v[50:51], v[84:85], v[66:67] op_sel:[0,1,0] op_sel_hi:[1,1,1]
    v_pk_fma_f32 v[202:203], v[54:55], v[84:85], v[70:71] op_sel:[0,1,0] op_sel_hi:[1,1,1]
    v_pk_fma_f32 v[192:193], v[136:137], v[84:85], v[192:193] op_sel:[0,0,0] op_sel_hi:[1,0,1]
    v_pk_fma_f32 v[194:195], v[140:141], v[84:85], v[194:195] op_sel:[0,0,0] op_sel_hi:[1,0,1]
    v_pk_fma_f32 v[200:201], v[138:139], v[84:85], v[200:201] op_sel:[0,0,0] op_sel_hi:[1,0,1]
    v_pk_fma_f32 v[202:203], v[142:143], v[84:85], v[202:203] op_sel:[0,0,0] op_sel_hi:[1,0,1]
    buffer_load_dwordx4 a[148:151], v7, s[32:35], s85 offen offset:2048
    v_pk_mul_f32 v[196:197], v[192:193], v[192:193]
    v_pk_mul_f32 v[204:205], v[200:201], v[200:201]
    v_pk_fma_f32 v[196:197], v[196:197], v[74:75], v[72:73]
    v_pk_fma_f32 v[204:205], v[204:205], v[74:75], v[72:73]
    v_pk_mul_f32 v[196:197], v[196:197], v[192:193]
    v_pk_mul_f32 v[204:205], v[204:205], v[200:201]
    v_exp_f32 v196, v196
    v_exp_f32 v197, v197
    v_exp_f32 v204, v204
    v_exp_f32 v205, v205
    v_pk_mul_f32 v[194:195], v[194:195], v[192:193]
    v_pk_mul_f32 v[202:203], v[202:203], v[200:201]
    v_pk_add_f32 v[196:197], v[196:197], 1.0 op_sel_hi:[1,0]
    v_pk_add_f32 v[204:205], v[204:205], 1.0 op_sel_hi:[1,0]
    v_rcp_f32 v196, v196
    v_rcp_f32 v197, v197
    v_rcp_f32 v204, v204
    v_rcp_f32 v205, v205
    v_pk_mul_f32 v[194:195], v[194:195], v[196:197]
    v_pk_mul_f32 v[202:203], v[202:203], v[204:205]
    v_cvt_pk_bf16_f32 v78, v194, v195
    v_cvt_pk_bf16_f32 v79, v202, v203
    buffer_store_dwordx4 v[76:79], v7, s[16:19], s80 offen offset:2048 sc0 sc1
    v_pk_fma_f32 v[192:193], v[40:41], v[86:87], v[56:57] op_sel:[0,1,0] op_sel_hi:[1,1,1]
    v_pk_fma_f32 v[194:195], v[44:45], v[86:87], v[60:61] op_sel:[0,1,0] op_sel_hi:[1,1,1]
    v_pk_fma_f32 v[200:201], v[42:43], v[86:87], v[58:59] op_sel:[0,1,0] op_sel_hi:[1,1,1]
    v_pk_fma_f32 v[202:203], v[46:47], v[86:87], v[62:63] op_sel:[0,1,0] op_sel_hi:[1,1,1]
    v_pk_fma_f32 v[192:193], v[176:177], v[86:87], v[192:193] op_sel:[0,0,0] op_sel_hi:[1,0,1]
    v_pk_fma_f32 v[194:195], v[180:181], v[86:87], v[194:195] op_sel:[0,0,0] op_sel_hi:[1,0,1]
    v_pk_fma_f32 v[200:201], v[178:179], v[86:87], v[200:201] op_sel:[0,0,0] op_sel_hi:[1,0,1]
    v_pk_fma_f32 v[202:203], v[182:183], v[86:87], v[202:203] op_sel:[0,0,0] op_sel_hi:[1,0,1]
    buffer_load_dwordx4 a[152:155], v7, s[32:35], s85 offen offset:3072
    v_pk_mul_f32 v[196:197], v[192:193], v[192:193]
    v_pk_mul_f32 v[204:205], v[200:201], v[200:201]
    v_pk_fma_f32 v[196:197], v[196:197], v[74:75], v[72:73]
    v_pk_fma_f32 v[204:205], v[204:205], v[74:75], v[72:73]
    v_pk_mul_f32 v[196:197], v[196:197], v[192:193]
    v_pk_mul_f32 v[204:205], v[204:205], v[200:201]
    v_exp_f32 v196, v196
    v_exp_f32 v197, v197
    v_exp_f32 v204, v204
    v_exp_f32 v205, v205
    v_pk_mul_f32 v[194:195], v[194:195], v[192:193]
    v_pk_mul_f32 v[202:203], v[202:203], v[200:201]
    v_pk_add_f32 v[196:197], v[196:197], 1.0 op_sel_hi:[1,0]
    v_pk_add_f32 v[204:205], v[204:205], 1.0 op_sel_hi:[1,0]
    v_rcp_f32 v196, v196
    v_rcp_f32 v197, v197
    v_rcp_f32 v204, v204
    v_rcp_f32 v205, v205
    v_pk_mul_f32 v[194:195], v[194:195], v[196:197]
    v_pk_mul_f32 v[202:203], v[202:203], v[204:205]
    v_cvt_pk_bf16_f32 v80, v194, v195
    v_cvt_pk_bf16_f32 v81, v202, v203
    v_pk_fma_f32 v[192:193], v[48:49], v[86:87], v[64:65] op_sel:[0,1,0] op_sel_hi:[1,1,1]
    v_pk_fma_f32 v[194:195], v[52:53], v[86:87], v[68:69] op_sel:[0,1,0] op_sel_hi:[1,1,1]
    v_pk_fma_f32 v[200:201], v[50:51], v[86:87], v[66:67] op_sel:[0,1,0] op_sel_hi:[1,1,1]
    v_pk_fma_f32 v[202:203], v[54:55], v[86:87], v[70:71] op_sel:[0,1,0] op_sel_hi:[1,1,1]
    v_pk_fma_f32 v[192:193], v[184:185], v[86:87], v[192:193] op_sel:[0,0,0] op_sel_hi:[1,0,1]
    v_pk_fma_f32 v[194:195], v[188:189], v[86:87], v[194:195] op_sel:[0,0,0] op_sel_hi:[1,0,1]
    v_pk_fma_f32 v[200:201], v[186:187], v[86:87], v[200:201] op_sel:[0,0,0] op_sel_hi:[1,0,1]
    v_pk_fma_f32 v[202:203], v[190:191], v[86:87], v[202:203] op_sel:[0,0,0] op_sel_hi:[1,0,1]
    s_add_u32 s85, s85, 4096
    buffer_load_dwordx4 a[156:159], v7, s[32:35], s85 offen
    v_pk_mul_f32 v[196:197], v[192:193], v[192:193]
    v_pk_mul_f32 v[204:205], v[200:201], v[200:201]
    v_pk_fma_f32 v[196:197], v[196:197], v[74:75], v[72:73]
    v_pk_fma_f32 v[204:205], v[204:205], v[74:75], v[72:73]
    v_pk_mul_f32 v[196:197], v[196:197], v[192:193]
    v_pk_mul_f32 v[204:205], v[204:205], v[200:201]
    v_exp_f32 v196, v196
    v_exp_f32 v197, v197
    v_exp_f32 v204, v204
    v_exp_f32 v205, v205
    v_pk_mul_f32 v[194:195], v[194:195], v[192:193]
    v_pk_mul_f32 v[202:203], v[202:203], v[200:201]
    v_pk_add_f32 v[196:197], v[196:197], 1.0 op_sel_hi:[1,0]
    v_pk_add_f32 v[204:205], v[204:205], 1.0 op_sel_hi:[1,0]
    v_rcp_f32 v196, v196
    v_rcp_f32 v197, v197
    v_rcp_f32 v204, v204
    v_rcp_f32 v205, v205
    v_pk_mul_f32 v[194:195], v[194:195], v[196:197]
    v_pk_mul_f32 v[202:203], v[202:203], v[204:205]
    v_cvt_pk_bf16_f32 v82, v194, v195
    v_cvt_pk_bf16_f32 v83, v202, v203
    buffer_store_dwordx4 v[80:83], v7, s[16:19], s81 offen offset:2048 sc0 sc1
    v_lshrrev_b32 v10, 1, v3
    v_lshlrev_b32 v10, 10, v10
    v_and_b32 v11, 1, v3
    v_lshlrev_b32 v11, 5, v11
    v_add_u32 v11, v11, v4
    v_lshl_add_u32 v10, v11, 4, v10
    v_add_u32 v11, 98304, v10
    s_lshl_b32 s80, s20, 7
    s_add_u32 s80, s80, 2048
    v_mov_b32 v88, 0
    v_mov_b32 v89, 1
    v_cmp_gt_u32 vcc, 1, v0
    s_nop 1
    v_cndmask_b32 v88, v29, v88, vcc
    s_mul_i32 s84, s27, 48
    s_add_u32 s84, s84, s22
    s_mul_i32 s84, s84, 5120
    s_waitcnt vmcnt(0)
    s_barrier
    s_cmp_lg_u32 s22, 0
    s_cbranch_scc1 L_k5_noatom
    buffer_atomic_add v89, v88, s[28:31], s80 offen sc1
L_k5_noatom:
    s_add_u32 s85, s84, 163840
    buffer_load_dwordx4 a[160:163], v7, s[32:35], s85 offen offset:0
    buffer_load_dwordx4 a[164:167], v7, s[32:35], s85 offen offset:1024
    buffer_load_dwordx4 a[168:171], v7, s[32:35], s85 offen offset:2048
    buffer_load_dwordx4 a[172:175], v7, s[32:35], s85 offen offset:3072
    s_add_u32 s85, s85, 4096
    buffer_load_dwordx4 a[176:179], v7, s[32:35], s85 offen
    s_add_u32 s85, s84, 184320
    buffer_load_dwordx4 a[180:183], v7, s[32:35], s85 offen offset:0
    buffer_load_dwordx4 a[184:187], v7, s[32:35], s85 offen offset:1024
    buffer_load_dwordx4 a[188:191], v7, s[32:35], s85 offen offset:2048
    buffer_load_dwordx4 a[192:195], v7, s[32:35], s85 offen offset:3072
    s_add_u32 s85, s85, 4096
    buffer_load_dwordx4 a[196:199], v7, s[32:35], s85 offen
    s_add_u32 s85, s84, 204800
    buffer_load_dwordx4 a[200:203], v7, s[32:35], s85 offen offset:0
    buffer_load_dwordx4 a[204:207], v7, s[32:35], s85 offen offset:1024
    buffer_load_dwordx4 a[208:211], v7, s[32:35], s85 offen offset:2048
    buffer_load_dwordx4 a[212:215], v7, s[32:35], s85 offen offset:3072
    s_add_u32 s85, s85, 4096
    buffer_load_dwordx4 a[216:219], v7, s[32:35], s85 offen
    s_add_u32 s85, s84, 225280
    buffer_load_dwordx4 a[220:223], v7, s[32:35], s85 offen offset:0
    buffer_load_dwordx4 a[224:227], v7, s[32:35], s85 offen offset:1024
    buffer_load_dwordx4 a[228:231], v7, s[32:35], s85 offen offset:2048
    buffer_load_dwordx4 a[232:235], v7, s[32:35], s85 offen offset:3072
    s_add_u32 s85, s85, 4096
    buffer_load_dwordx4 a[236:239], v7, s[32:35], s85 offen
    s_cmp_lg_u32 s22, 0
    s_cbranch_scc1 L_k5_a_ok
    s_mov_b32 s76, 0
    v_mov_b32 v88, 0
L_k5_a_spin:
    buffer_load_dword v90, v88, s[28:31], s80 offen sc0 sc1
    s_waitcnt vmcnt(0)
    v_readfirstlane_b32 s81, v90
    s_add_u32 s76, s76, 1
    s_nop 2
    s_cmp_eq_u32 s81, 16
    s_cbranch_scc1 L_k5_a_ok
    s_cmp_lt_u32 s76, 400000
    s_cbranch_scc1 L_k5_a_spin
L_k5_a_ok:
    s_mul_i32 s84, s3, 2*96
    s_lshl_b32 s85, s22, 1
    s_add_u32 s84, s84, s85
    s_lshl_b32 s84, s84, 10
    s_barrier
    buffer_load_dwordx4 v[16:19], v10, s[16:19], s84 offen sc0 sc1
    buffer_load_dwordx4 v[20:23], v10, s[16:19], s84 offen offset:256 sc0 sc1
    buffer_load_dwordx4 v[24:27], v11, s[16:19], s84 offen sc0 sc1
    buffer_load_dwordx4 v[28:31], v11, s[16:19], s84 offen offset:256 sc0 sc1
    s_add_u32 s84, s84, 8192
    buffer_load_dwordx4 v[32:35], v10, s[16:19], s84 offen sc0 sc1
    buffer_load_dwordx4 v[36:39], v10, s[16:19], s84 offen offset:256 sc0 sc1
    buffer_load_dwordx4 v[40:43], v11, s[16:19], s84 offen sc0 sc1
    buffer_load_dwordx4 v[44:47], v11, s[16:19], s84 offen offset:256 sc0 sc1
    s_add_u32 s84, s84, 8192
    buffer_load_dwordx4 v[48:51], v10, s[16:19], s84 offen sc0 sc1
    buffer_load_dwordx4 v[52:55], v10, s[16:19], s84 offen offset:256 sc0 sc1
    buffer_load_dwordx4 v[56:59], v11, s[16:19], s84 offen sc0 sc1
    buffer_load_dwordx4 v[60:63], v11, s[16:19], s84 offen offset:256 sc0 sc1
    s_add_u32 s84, s84, 8192
    buffer_load_dwordx4 v[64:67], v10, s[16:19], s84 offen sc0 sc1
    buffer_load_dwordx4 v[68:71], v10, s[16:19], s84 offen offset:256 sc0 sc1
    buffer_load_dwordx4 v[72:75], v11, s[16:19], s84 offen sc0 sc1
    buffer_load_dwordx4 v[76:79], v11, s[16:19], s84 offen offset:256 sc0 sc1
    s_add_u32 s84, s84, 8192
    buffer_load_dwordx4 v[80:83], v10, s[16:19], s84 offen sc0 sc1
    buffer_load_dwordx4 v[84:87], v10, s[16:19], s84 offen offset:256 sc0 sc1
    buffer_load_dwordx4 v[88:91], v11, s[16:19], s84 offen sc0 sc1
    buffer_load_dwordx4 v[92:95], v11, s[16:19], s84 offen offset:256 sc0 sc1
    s_add_u32 s84, s84, 8192
    buffer_load_dwordx4 v[96:99], v10, s[16:19], s84 offen sc0 sc1
    buffer_load_dwordx4 v[100:103], v10, s[16:19], s84 offen offset:256 sc0 sc1
    buffer_load_dwordx4 v[104:107], v11, s[16:19], s84 offen sc0 sc1
    buffer_load_dwordx4 v[108:111], v11, s[16:19], s84 offen offset:256 sc0 sc1
    s_add_u32 s84, s84, 8192
    s_mul_i32 s80, s22, 20480
    v_add_u32 v124, s80, v7
    s_mov_b32 s76, s82
    s_mov_b32 s77, s83
    s_mov_b32 s78, 2621440
    s_mov_b32 s79, 0x20000
    s_lshl_b32 s80, s22, 10
    v_add_u32 v125, s80, v7
    v_add_u32 v126, 40960, v125
    v_lshrrev_b32 v120, 2, v4
    v_and_b32 v121, 3, v4
    v_lshl_add_u32 v120, v3, 2, v120
    v_lshlrev_b32 v120, 7, v120
    v_lshl_add_u32 v120, v121, 3, v120
    s_lshl_b32 s80, s22, 5
    s_add_u32 s80, s80, 144896
    v_add_u32 v120, s80, v120
    v_lshlrev_b32 v121, 4, v3
    v_add_u32 v121, 155136, v121
    s_lshl_b32 s80, s3, 6
    s_lshl_b32 s81, s22, 4
    s_add_u32 s80, s80, s81
    v_add_u32 v122, s80, v4
    v_mul_u32_u24 v122, 1280, v122
    s_mul_i32 s80, s27, 160
    v_lshl_add_u32 v122, v3, 3, v122
    v_add_u32 v122, s80, v122
    ds_read_b64_tr_b16 v[228:229], v120 offset:0
    ds_read_b64_tr_b16 v[230:231], v120 offset:2048
    ds_read_b64_tr_b16 v[232:233], v120 offset:4096
    ds_read_b64_tr_b16 v[234:235], v120 offset:6144
    ds_read_b64_tr_b16 v[236:237], v120 offset:8192
    ds_read_b128 v[208:211], v121 offset:0
    ds_read_b128 v[212:215], v121 offset:64
    ds_read_b128 v[216:219], v121 offset:128
    ds_read_b128 v[220:223], v121 offset:192
    ds_read_b128 v[224:227], v121 offset:256
    s_waitcnt vmcnt(23)
    v_mfma_f32_16x16x32_bf16 v[128:131], a[0:3], v[16:19], 0
    v_mfma_f32_16x16x32_bf16 v[144:147], a[4:7], v[16:19], 0
    v_mfma_f32_16x16x32_bf16 v[160:163], a[8:11], v[16:19], 0
    v_mfma_f32_16x16x32_bf16 v[176:179], a[12:15], v[16:19], 0
    v_mfma_f32_16x16x32_bf16 v[192:195], a[16:19], v[16:19], 0
    buffer_load_dwordx4 v[16:19], v10, s[16:19], s84 offen sc0 sc1
    s_waitcnt vmcnt(23)
    v_mfma_f32_16x16x32_bf16 v[132:135], a[0:3], v[20:23], 0
    v_mfma_f32_16x16x32_bf16 v[148:151], a[4:7], v[20:23], 0
    v_mfma_f32_16x16x32_bf16 v[164:167], a[8:11], v[20:23], 0
    v_mfma_f32_16x16x32_bf16 v[180:183], a[12:15], v[20:23], 0
    v_mfma_f32_16x16x32_bf16 v[196:199], a[16:19], v[20:23], 0
    buffer_load_dwordx4 v[20:23], v10, s[16:19], s84 offen offset:256 sc0 sc1
    s_waitcnt vmcnt(23)
    v_mfma_f32_16x16x32_bf16 v[136:139], a[0:3], v[24:27], 0
    v_mfma_f32_16x16x32_bf16 v[152:155], a[4:7], v[24:27], 0
    v_mfma_f32_16x16x32_bf16 v[168:171], a[8:11], v[24:27], 0
    v_mfma_f32_16x16x32_bf16 v[184:187], a[12:15], v[24:27], 0
    v_mfma_f32_16x16x32_bf16 v[200:203], a[16:19], v[24:27], 0
    buffer_load_dwordx4 v[24:27], v11, s[16:19], s84 offen sc0 sc1
    s_waitcnt vmcnt(23)
    v_mfma_f32_16x16x32_bf16 v[140:143], a[0:3], v[28:31], 0
    v_mfma_f32_16x16x32_bf16 v[156:159], a[4:7], v[28:31], 0
    v_mfma_f32_16x16x32_bf16 v[172:175], a[8:11], v[28:31], 0
    v_mfma_f32_16x16x32_bf16 v[188:191], a[12:15], v[28:31], 0
    v_mfma_f32_16x16x32_bf16 v[204:207], a[16:19], v[28:31], 0
    buffer_load_dwordx4 v[28:31], v11, s[16:19], s84 offen offset:256 sc0 sc1
    s_add_u32 s84, s84, 8192
    s_waitcnt vmcnt(23)
    v_mfma_f32_16x16x32_bf16 v[128:131], a[20:23], v[32:35], v[128:131]
    v_mfma_f32_16x16x32_bf16 v[144:147], a[24:27], v[32:35], v[144:147]
    v_mfma_f32_16x16x32_bf16 v[160:163], a[28:31], v[32:35], v[160:163]
    v_mfma_f32_16x16x32_bf16 v[176:179], a[32:35], v[32:35], v[176:179]
    v_mfma_f32_16x16x32_bf16 v[192:195], a[36:39], v[32:35], v[192:195]
    buffer_load_dwordx4 v[32:35], v10, s[16:19], s84 offen sc0 sc1
    s_waitcnt vmcnt(23)
    v_mfma_f32_16x16x32_bf16 v[132:135], a[20:23], v[36:39], v[132:135]
    v_mfma_f32_16x16x32_bf16 v[148:151], a[24:27], v[36:39], v[148:151]
    v_mfma_f32_16x16x32_bf16 v[164:167], a[28:31], v[36:39], v[164:167]
    v_mfma_f32_16x16x32_bf16 v[180:183], a[32:35], v[36:39], v[180:183]
    v_mfma_f32_16x16x32_bf16 v[196:199], a[36:39], v[36:39], v[196:199]
    buffer_load_dwordx4 v[36:39], v10, s[16:19], s84 offen offset:256 sc0 sc1
    s_waitcnt vmcnt(23)
    v_mfma_f32_16x16x32_bf16 v[136:139], a[20:23], v[40:43], v[136:139]
    v_mfma_f32_16x16x32_bf16 v[152:155], a[24:27], v[40:43], v[152:155]
    v_mfma_f32_16x16x32_bf16 v[168:171], a[28:31], v[40:43], v[168:171]
    v_mfma_f32_16x16x32_bf16 v[184:187], a[32:35], v[40:43], v[184:187]
    v_mfma_f32_16x16x32_bf16 v[200:203], a[36:39], v[40:43], v[200:203]
    buffer_load_dwordx4 v[40:43], v11, s[16:19], s84 offen sc0 sc1
    s_waitcnt vmcnt(23)
    v_mfma_f32_16x16x32_bf16 v[140:143], a[20:23], v[44:47], v[140:143]
    v_mfma_f32_16x16x32_bf16 v[156:159], a[24:27], v[44:47], v[156:159]
    v_mfma_f32_16x16x32_bf16 v[172:175], a[28:31], v[44:47], v[172:175]
    v_mfma_f32_16x16x32_bf16 v[188:191], a[32:35], v[44:47], v[188:191]
    v_mfma_f32_16x16x32_bf16 v[204:207], a[36:39], v[44:47], v[204:207]
    buffer_load_dwordx4 v[44:47], v11, s[16:19], s84 offen offset:256 sc0 sc1
    s_add_u32 s84, s84, 8192
    s_waitcnt vmcnt(23)
    v_mfma_f32_16x16x32_bf16 v[128:131], a[40:43], v[48:51], v[128:131]
    v_mfma_f32_16x16x32_bf16 v[144:147], a[44:47], v[48:51], v[144:147]
    v_mfma_f32_16x16x32_bf16 v[160:163], a[48:51], v[48:51], v[160:163]
    v_mfma_f32_16x16x32_bf16 v[176:179], a[52:55], v[48:51], v[176:179]
    v_mfma_f32_16x16x32_bf16 v[192:195], a[56:59], v[48:51], v[192:195]
    buffer_load_dwordx4 v[48:51], v10, s[16:19], s84 offen sc0 sc1
    s_waitcnt vmcnt(23)
    v_mfma_f32_16x16x32_bf16 v[132:135], a[40:43], v[52:55], v[132:135]
    v_mfma_f32_16x16x32_bf16 v[148:151], a[44:47], v[52:55], v[148:151]
    v_mfma_f32_16x16x32_bf16 v[164:167], a[48:51], v[52:55], v[164:167]
    v_mfma_f32_16x16x32_bf16 v[180:183], a[52:55], v[52:55], v[180:183]
    v_mfma_f32_16x16x32_bf16 v[196:199], a[56:59], v[52:55], v[196:199]
    buffer_load_dwordx4 v[52:55], v10, s[16:19], s84 offen offset:256 sc0 sc1
    s_waitcnt vmcnt(23)
    v_mfma_f32_16x16x32_bf16 v[136:139], a[40:43], v[56:59], v[136:139]
    v_mfma_f32_16x16x32_bf16 v[152:155], a[44:47], v[56:59], v[152:155]
    v_mfma_f32_16x16x32_bf16 v[168:171], a[48:51], v[56:59], v[168:171]
    v_mfma_f32_16x16x32_bf16 v[184:187], a[52:55], v[56:59], v[184:187]
    v_mfma_f32_16x16x32_bf16 v[200:203], a[56:59], v[56:59], v[200:203]
    buffer_load_dwordx4 v[56:59], v11, s[16:19], s84 offen sc0 sc1
    s_waitcnt vmcnt(23)
    v_mfma_f32_16x16x32_bf16 v[140:143], a[40:43], v[60:63], v[140:143]
    v_mfma_f32_16x16x32_bf16 v[156:159], a[44:47], v[60:63], v[156:159]
    v_mfma_f32_16x16x32_bf16 v[172:175], a[48:51], v[60:63], v[172:175]
    v_mfma_f32_16x16x32_bf16 v[188:191], a[52:55], v[60:63], v[188:191]
    v_mfma_f32_16x16x32_bf16 v[204:207], a[56:59], v[60:63], v[204:207]
    buffer_load_dwordx4 v[60:63], v11, s[16:19], s84 offen offset:256 sc0 sc1
    s_add_u32 s84, s84, 8192
    s_waitcnt vmcnt(23)
    v_mfma_f32_16x16x32_bf16 v[128:131], a[60:63], v[64:67], v[128:131]
    v_mfma_f32_16x16x32_bf16 v[144:147], a[64:67], v[64:67], v[144:147]
    v_mfma_f32_16x16x32_bf16 v[160:163], a[68:71], v[64:67], v[160:163]
    v_mfma_f32_16x16x32_bf16 v[176:179], a[72:75], v[64:67], v[176:179]
    v_mfma_f32_16x16x32_bf16 v[192:195], a[76:79], v[64:67], v[192:195]
    buffer_load_dwordx4 v[64:67], v10, s[16:19], s84 offen sc0 sc1
    s_waitcnt vmcnt(23)
    v_mfma_f32_16x16x32_bf16 v[132:135], a[60:63], v[68:71], v[132:135]
    v_mfma_f32_16x16x32_bf16 v[148:151], a[64:67], v[68:71], v[148:151]
    v_mfma_f32_16x16x32_bf16 v[164:167], a[68:71], v[68:71], v[164:167]
    v_mfma_f32_16x16x32_bf16 v[180:183], a[72:75], v[68:71], v[180:183]
    v_mfma_f32_16x16x32_bf16 v[196:199], a[76:79], v[68:71], v[196:199]
    buffer_load_dwordx4 v[68:71], v10, s[16:19], s84 offen offset:256 sc0 sc1
    s_waitcnt vmcnt(23)
    v_mfma_f32_16x16x32_bf16 v[136:139], a[60:63], v[72:75], v[136:139]
    v_mfma_f32_16x16x32_bf16 v[152:155], a[64:67], v[72:75], v[152:155]
    v_mfma_f32_16x16x32_bf16 v[168:171], a[68:71], v[72:75], v[168:171]
    v_mfma_f32_16x16x32_bf16 v[184:187], a[72:75], v[72:75], v[184:187]
    v_mfma_f32_16x16x32_bf16 v[200:203], a[76:79], v[72:75], v[200:203]
    buffer_load_dwordx4 v[72:75], v11, s[16:19], s84 offen sc0 sc1
    s_waitcnt vmcnt(23)
    v_mfma_f32_16x16x32_bf16 v[140:143], a[60:63], v[76:79], v[140:143]
    v_mfma_f32_16x16x32_bf16 v[156:159], a[64:67], v[76:79], v[156:159]
    v_mfma_f32_16x16x32_bf16 v[172:175], a[68:71], v[76:79], v[172:175]
    v_mfma_f32_16x16x32_bf16 v[188:191], a[72:75], v[76:79], v[188:191]
    v_mfma_f32_16x16x32_bf16 v[204:207], a[76:79], v[76:79], v[204:207]
    buffer_load_dwordx4 v[76:79], v11, s[16:19], s84 offen offset:256 sc0 sc1
    s_add_u32 s84, s84, 8192
    s_waitcnt vmcnt(23)
    v_mfma_f32_16x16x32_bf16 v[128:131], a[80:83], v[80:83], v[128:131]
    v_mfma_f32_16x16x32_bf16 v[144:147], a[84:87], v[80:83], v[144:147]
    v_mfma_f32_16x16x32_bf16 v[160:163], a[88:91], v[80:83], v[160:163]
    v_mfma_f32_16x16x32_bf16 v[176:179], a[92:95], v[80:83], v[176:179]
    v_mfma_f32_16x16x32_bf16 v[192:195], a[96:99], v[80:83], v[192:195]
    buffer_load_dwordx4 v[80:83], v10, s[16:19], s84 offen sc0 sc1
    s_waitcnt vmcnt(23)
    v_mfma_f32_16x16x32_bf16 v[132:135], a[80:83], v[84:87], v[132:135]
    v_mfma_f32_16x16x32_bf16 v[148:151], a[84:87], v[84:87], v[148:151]
    v_mfma_f32_16x16x32_bf16 v[164:167], a[88:91], v[84:87], v[164:167]
    v_mfma_f32_16x16x32_bf16 v[180:183], a[92:95], v[84:87], v[180:183]
    v_mfma_f32_16x16x32_bf16 v[196:199], a[96:99], v[84:87], v[196:199]
    buffer_load_dwordx4 v[84:87], v10, s[16:19], s84 offen offset:256 sc0 sc1
    s_waitcnt vmcnt(23)
    v_mfma_f32_16x16x32_bf16 v[136:139], a[80:83], v[88:91], v[136:139]
    v_mfma_f32_16x16x32_bf16 v[152:155], a[84:87], v[88:91], v[152:155]
    v_mfma_f32_16x16x32_bf16 v[168:171], a[88:91], v[88:91], v[168:171]
    v_mfma_f32_16x16x32_bf16 v[184:187], a[92:95], v[88:91], v[184:187]
    v_mfma_f32_16x16x32_bf16 v[200:203], a[96:99], v[88:91], v[200:203]
    buffer_load_dwordx4 v[88:91], v11, s[16:19], s84 offen sc0 sc1
    s_waitcnt vmcnt(23)
    v_mfma_f32_16x16x32_bf16 v[140:143], a[80:83], v[92:95], v[140:143]
    v_mfma_f32_16x16x32_bf16 v[156:159], a[84:87], v[92:95], v[156:159]
    v_mfma_f32_16x16x32_bf16 v[172:175], a[88:91], v[92:95], v[172:175]
    v_mfma_f32_16x16x32_bf16 v[188:191], a[92:95], v[92:95], v[188:191]
    v_mfma_f32_16x16x32_bf16 v[204:207], a[96:99], v[92:95], v[204:207]
    buffer_load_dwordx4 v[92:95], v11, s[16:19], s84 offen offset:256 sc0 sc1
    s_add_u32 s84, s84, 8192
    s_waitcnt vmcnt(23)
    v_mfma_f32_16x16x32_bf16 v[128:131], a[100:103], v[96:99], v[128:131]
    v_mfma_f32_16x16x32_bf16 v[144:147], a[104:107], v[96:99], v[144:147]
    v_mfma_f32_16x16x32_bf16 v[160:163], a[108:111], v[96:99], v[160:163]
    v_mfma_f32_16x16x32_bf16 v[176:179], a[112:115], v[96:99], v[176:179]
    v_mfma_f32_16x16x32_bf16 v[192:195], a[116:119], v[96:99], v[192:195]
    buffer_load_dwordx4 v[96:99], v10, s[16:19], s84 offen sc0 sc1
    s_waitcnt vmcnt(23)
    v_mfma_f32_16x16x32_bf16 v[132:135], a[100:103], v[100:103], v[132:135]
    v_mfma_f32_16x16x32_bf16 v[148:151], a[104:107], v[100:103], v[148:151]
    v_mfma_f32_16x16x32_bf16 v[164:167], a[108:111], v[100:103], v[164:167]
    v_mfma_f32_16x16x32_bf16 v[180:183], a[112:115], v[100:103], v[180:183]
    v_mfma_f32_16x16x32_bf16 v[196:199], a[116:119], v[100:103], v[196:199]
    buffer_load_dwordx4 v[100:103], v10, s[16:19], s84 offen offset:256 sc0 sc1
    s_waitcnt vmcnt(23)
    v_mfma_f32_16x16x32_bf16 v[136:139], a[100:103], v[104:107], v[136:139]
    v_mfma_f32_16x16x32_bf16 v[152:155], a[104:107], v[104:107], v[152:155]
    v_mfma_f32_16x16x32_bf16 v[168:171], a[108:111], v[104:107], v[168:171]
    v_mfma_f32_16x16x32_bf16 v[184:187], a[112:115], v[104:107], v[184:187]
    v_mfma_f32_16x16x32_bf16 v[200:203], a[116:119], v[104:107], v[200:203]
    buffer_load_dwordx4 v[104:107], v11, s[16:19], s84 offen sc0 sc1
    s_waitcnt vmcnt(23)
    v_mfma_f32_16x16x32_bf16 v[140:143], a[100:103], v[108:111], v[140:143]
    v_mfma_f32_16x16x32_bf16 v[156:159], a[104:107], v[108:111], v[156:159]
    v_mfma_f32_16x16x32_bf16 v[172:175], a[108:111], v[108:111], v[172:175]
    v_mfma_f32_16x16x32_bf16 v[188:191], a[112:115], v[108:111], v[188:191]
    v_mfma_f32_16x16x32_bf16 v[204:207], a[116:119], v[108:111], v[204:207]
    buffer_load_dwordx4 v[108:111], v11, s[16:19], s84 offen offset:256 sc0 sc1
    s_add_u32 s84, s84, 8192
    s_waitcnt vmcnt(23)
    v_mfma_f32_16x16x32_bf16 v[128:131], a[120:123], v[16:19], v[128:131]
    v_mfma_f32_16x16x32_bf16 v[144:147], a[124:127], v[16:19], v[144:147]
    v_mfma_f32_16x16x32_bf16 v[160:163], a[128:131], v[16:19], v[160:163]
    v_mfma_f32_16x16x32_bf16 v[176:179], a[132:135], v[16:19], v[176:179]
    v_mfma_f32_16x16x32_bf16 v[192:195], a[136:139], v[16:19], v[192:195]
    s_waitcnt vmcnt(22)
    v_mfma_f32_16x16x32_bf16 v[132:135], a[120:123], v[20:23], v[132:135]
    v_mfma_f32_16x16x32_bf16 v[148:151], a[124:127], v[20:23], v[148:151]
    v_mfma_f32_16x16x32_bf16 v[164:167], a[128:131], v[20:23], v[164:167]
    v_mfma_f32_16x16x32_bf16 v[180:183], a[132:135], v[20:23], v[180:183]
    v_mfma_f32_16x16x32_bf16 v[196:199], a[136:139], v[20:23], v[196:199]
    s_waitcnt vmcnt(21)
    v_mfma_f32_16x16x32_bf16 v[136:139], a[120:123], v[24:27], v[136:139]
    v_mfma_f32_16x16x32_bf16 v[152:155], a[124:127], v[24:27], v[152:155]
    v_mfma_f32_16x16x32_bf16 v[168:171], a[128:131], v[24:27], v[168:171]
    v_mfma_f32_16x16x32_bf16 v[184:187], a[132:135], v[24:27], v[184:187]
    v_mfma_f32_16x16x32_bf16 v[200:203], a[136:139], v[24:27], v[200:203]
    s_waitcnt vmcnt(20)
    v_mfma_f32_16x16x32_bf16 v[140:143], a[120:123], v[28:31], v[140:143]
    v_mfma_f32_16x16x32_bf16 v[156:159], a[124:127], v[28:31], v[156:159]
    v_mfma_f32_16x16x32_bf16 v[172:175], a[128:131], v[28:31], v[172:175]
    v_mfma_f32_16x16x32_bf16 v[188:191], a[132:135], v[28:31], v[188:191]
    v_mfma_f32_16x16x32_bf16 v[204:207], a[136:139], v[28:31], v[204:207]
    s_waitcnt vmcnt(19)
    v_mfma_f32_16x16x32_bf16 v[128:131], a[140:143], v[32:35], v[128:131]
    v_mfma_f32_16x16x32_bf16 v[144:147], a[144:147], v[32:35], v[144:147]
    v_mfma_f32_16x16x32_bf16 v[160:163], a[148:151], v[32:35], v[160:163]
    v_mfma_f32_16x16x32_bf16 v[176:179], a[152:155], v[32:35], v[176:179]
    v_mfma_f32_16x16x32_bf16 v[192:195], a[156:159], v[32:35], v[192:195]
    s_waitcnt vmcnt(18)
    v_mfma_f32_16x16x32_bf16 v[132:135], a[140:143], v[36:39], v[132:135]
    v_mfma_f32_16x16x32_bf16 v[148:151], a[144:147], v[36:39], v[148:151]
    v_mfma_f32_16x16x32_bf16 v[164:167], a[148:151], v[36:39], v[164:167]
    v_mfma_f32_16x16x32_bf16 v[180:183], a[152:155], v[36:39], v[180:183]
    v_mfma_f32_16x16x32_bf16 v[196:199], a[156:159], v[36:39], v[196:199]
    s_waitcnt vmcnt(17)
    v_mfma_f32_16x16x32_bf16 v[136:139], a[140:143], v[40:43], v[136:139]
    v_mfma_f32_16x16x32_bf16 v[152:155], a[144:147], v[40:43], v[152:155]
    v_mfma_f32_16x16x32_bf16 v[168:171], a[148:151], v[40:43], v[168:171]
    v_mfma_f32_16x16x32_bf16 v[184:187], a[152:155], v[40:43], v[184:187]
    v_mfma_f32_16x16x32_bf16 v[200:203], a[156:159], v[40:43], v[200:203]
    s_waitcnt vmcnt(16)
    v_mfma_f32_16x16x32_bf16 v[140:143], a[140:143], v[44:47], v[140:143]
    v_mfma_f32_16x16x32_bf16 v[156:159], a[144:147], v[44:47], v[156:159]
    v_mfma_f32_16x16x32_bf16 v[172:175], a[148:151], v[44:47], v[172:175]
    v_mfma_f32_16x16x32_bf16 v[188:191], a[152:155], v[44:47], v[188:191]
    v_mfma_f32_16x16x32_bf16 v[204:207], a[156:159], v[44:47], v[204:207]
    s_waitcnt vmcnt(15)
    v_mfma_f32_16x16x32_bf16 v[128:131], a[160:163], v[48:51], v[128:131]
    v_mfma_f32_16x16x32_bf16 v[144:147], a[164:167], v[48:51], v[144:147]
    v_mfma_f32_16x16x32_bf16 v[160:163], a[168:171], v[48:51], v[160:163]
    v_mfma_f32_16x16x32_bf16 v[176:179], a[172:175], v[48:51], v[176:179]
    v_mfma_f32_16x16x32_bf16 v[192:195], a[176:179], v[48:51], v[192:195]
    s_waitcnt vmcnt(14)
    v_mfma_f32_16x16x32_bf16 v[132:135], a[160:163], v[52:55], v[132:135]
    v_mfma_f32_16x16x32_bf16 v[148:151], a[164:167], v[52:55], v[148:151]
    v_mfma_f32_16x16x32_bf16 v[164:167], a[168:171], v[52:55], v[164:167]
    v_mfma_f32_16x16x32_bf16 v[180:183], a[172:175], v[52:55], v[180:183]
    v_mfma_f32_16x16x32_bf16 v[196:199], a[176:179], v[52:55], v[196:199]
    s_waitcnt vmcnt(13)
    v_mfma_f32_16x16x32_bf16 v[136:139], a[160:163], v[56:59], v[136:139]
    v_mfma_f32_16x16x32_bf16 v[152:155], a[164:167], v[56:59], v[152:155]
    v_mfma_f32_16x16x32_bf16 v[168:171], a[168:171], v[56:59], v[168:171]
    v_mfma_f32_16x16x32_bf16 v[184:187], a[172:175], v[56:59], v[184:187]
    v_mfma_f32_16x16x32_bf16 v[200:203], a[176:179], v[56:59], v[200:203]
    s_waitcnt vmcnt(12)
    v_mfma_f32_16x16x32_bf16 v[140:143], a[160:163], v[60:63], v[140:143]
    v_mfma_f32_16x16x32_bf16 v[156:159], a[164:167], v[60:63], v[156:159]
    v_mfma_f32_16x16x32_bf16 v[172:175], a[168:171], v[60:63], v[172:175]
    v_mfma_f32_16x16x32_bf16 v[188:191], a[172:175], v[60:63], v[188:191]
    v_mfma_f32_16x16x32_bf16 v[204:207], a[176:179], v[60:63], v[204:207]
    s_waitcnt vmcnt(11)
    v_mfma_f32_16x16x32_bf16 v[128:131], a[180:183], v[64:67], v[128:131]
    v_mfma_f32_16x16x32_bf16 v[144:147], a[184:187], v[64:67], v[144:147]
    v_mfma_f32_16x16x32_bf16 v[160:163], a[188:191], v[64:67], v[160:163]
    v_mfma_f32_16x16x32_bf16 v[176:179], a[192:195], v[64:67], v[176:179]
    v_mfma_f32_16x16x32_bf16 v[192:195], a[196:199], v[64:67], v[192:195]
    s_waitcnt vmcnt(10)
    v_mfma_f32_16x16x32_bf16 v[132:135], a[180:183], v[68:71], v[132:135]
    v_mfma_f32_16x16x32_bf16 v[148:151], a[184:187], v[68:71], v[148:151]
    v_mfma_f32_16x16x32_bf16 v[164:167], a[188:191], v[68:71], v[164:167]
    v_mfma_f32_16x16x32_bf16 v[180:183], a[192:195], v[68:71], v[180:183]
    v_mfma_f32_16x16x32_bf16 v[196:199], a[196:199], v[68:71], v[196:199]
    s_waitcnt vmcnt(9)
    v_mfma_f32_16x16x32_bf16 v[136:139], a[180:183], v[72:75], v[136:139]
    v_mfma_f32_16x16x32_bf16 v[152:155], a[184:187], v[72:75], v[152:155]
    v_mfma_f32_16x16x32_bf16 v[168:171], a[188:191], v[72:75], v[168:171]
    v_mfma_f32_16x16x32_bf16 v[184:187], a[192:195], v[72:75], v[184:187]
    v_mfma_f32_16x16x32_bf16 v[200:203], a[196:199], v[72:75], v[200:203]
    s_waitcnt vmcnt(8)
    v_mfma_f32_16x16x32_bf16 v[140:143], a[180:183], v[76:79], v[140:143]
    v_mfma_f32_16x16x32_bf16 v[156:159], a[184:187], v[76:79], v[156:159]
    v_mfma_f32_16x16x32_bf16 v[172:175], a[188:191], v[76:79], v[172:175]
    v_mfma_f32_16x16x32_bf16 v[188:191], a[192:195], v[76:79], v[188:191]
    v_mfma_f32_16x16x32_bf16 v[204:207], a[196:199], v[76:79], v[204:207]
    s_waitcnt vmcnt(7)
    s_waitcnt vmcnt(3)
    v_mfma_f32_16x16x32_bf16 v[128:131], a[200:203], v[80:83], v[128:131]
    v_mfma_f32_16x16x32_bf16 v[144:147], a[204:207], v[80:83], v[144:147]
    v_mfma_f32_16x16x32_bf16 v[160:163], a[208:211], v[80:83], v[160:163]
    v_mfma_f32_16x16x32_bf16 v[176:179], a[212:215], v[80:83], v[176:179]
    v_mfma_f32_16x16x32_bf16 v[192:195], a[216:219], v[80:83], v[192:195]
    v_mfma_f32_16x16x32_bf16 v[128:131], a[220:223], v[96:99], v[128:131]
    v_mfma_f32_16x16x32_bf16 v[144:147], a[224:227], v[96:99], v[144:147]
    v_mfma_f32_16x16x32_bf16 v[160:163], a[228:231], v[96:99], v[160:163]
    v_mfma_f32_16x16x32_bf16 v[176:179], a[232:235], v[96:99], v[176:179]
    v_mfma_f32_16x16x32_bf16 v[192:195], a[236:239], v[96:99], v[192:195]
    s_waitcnt vmcnt(2)
    v_mfma_f32_16x16x32_bf16 v[132:135], a[200:203], v[84:87], v[132:135]
    v_mfma_f32_16x16x32_bf16 v[148:151], a[204:207], v[84:87], v[148:151]
    v_mfma_f32_16x16x32_bf16 v[164:167], a[208:211], v[84:87], v[164:167]
    v_mfma_f32_16x16x32_bf16 v[180:183], a[212:215], v[84:87], v[180:183]
    v_mfma_f32_16x16x32_bf16 v[196:199], a[216:219], v[84:87], v[196:199]
    ds_write_b128 v124, v[128:131] offset:0
    v_mfma_f32_16x16x32_bf16 v[132:135], a[220:223], v[100:103], v[132:135]
    ds_write_b128 v124, v[144:147] offset:4096
    v_mfma_f32_16x16x32_bf16 v[148:151], a[224:227], v[100:103], v[148:151]
    ds_write_b128 v124, v[160:163] offset:8192
    v_mfma_f32_16x16x32_bf16 v[164:167], a[228:231], v[100:103], v[164:167]
    ds_write_b128 v124, v[176:179] offset:12288
    v_mfma_f32_16x16x32_bf16 v[180:183], a[232:235], v[100:103], v[180:183]
    ds_write_b128 v124, v[192:195] offset:16384
    v_mfma_f32_16x16x32_bf16 v[196:199], a[236:239], v[100:103], v[196:199]
    s_waitcnt vmcnt(1)
    v_mfma_f32_16x16x32_bf16 v[136:139], a[200:203], v[88:91], v[136:139]
    v_mfma_f32_16x16x32_bf16 v[152:155], a[204:207], v[88:91], v[152:155]
    v_mfma_f32_16x16x32_bf16 v[168:171], a[208:211], v[88:91], v[168:171]
    v_mfma_f32_16x16x32_bf16 v[184:187], a[212:215], v[88:91], v[184:187]
    v_mfma_f32_16x16x32_bf16 v[200:203], a[216:219], v[88:91], v[200:203]
    ds_write_b128 v124, v[132:135] offset:1024
    v_mfma_f32_16x16x32_bf16 v[136:139], a[220:223], v[104:107], v[136:139]
    ds_write_b128 v124, v[148:151] offset:5120
    v_mfma_f32_16x16x32_bf16 v[152:155], a[224:227], v[104:107], v[152:155]
    ds_write_b128 v124, v[164:167] offset:9216
    v_mfma_f32_16x16x32_bf16 v[168:171], a[228:231], v[104:107], v[168:171]
    ds_write_b128 v124, v[180:183] offset:13312
    v_mfma_f32_16x16x32_bf16 v[184:187], a[232:235], v[104:107], v[184:187]
    ds_write_b128 v124, v[196:199] offset:17408
    v_mfma_f32_16x16x32_bf16 v[200:203], a[236:239], v[104:107], v[200:203]
    s_waitcnt vmcnt(0)
    v_mfma_f32_16x16x32_bf16 v[140:143], a[200:203], v[92:95], v[140:143]
    v_mfma_f32_16x16x32_bf16 v[156:159], a[204:207], v[92:95], v[156:159]
    v_mfma_f32_16x16x32_bf16 v[172:175], a[208:211], v[92:95], v[172:175]
    v_mfma_f32_16x16x32_bf16 v[188:191], a[212:215], v[92:95], v[188:191]
    v_mfma_f32_16x16x32_bf16 v[204:207], a[216:219], v[92:95], v[204:207]
    ds_write_b128 v124, v[136:139] offset:2048
    v_mfma_f32_16x16x32_bf16 v[140:143], a[220:223], v[108:111], v[140:143]
    ds_write_b128 v124, v[152:155] offset:6144
    v_mfma_f32_16x16x32_bf16 v[156:159], a[224:227], v[108:111], v[156:159]
    ds_write_b128 v124, v[168:171] offset:10240
    v_mfma_f32_16x16x32_bf16 v[172:175], a[228:231], v[108:111], v[172:175]
    ds_write_b128 v124, v[184:187] offset:14336
    v_mfma_f32_16x16x32_bf16 v[188:191], a[232:235], v[108:111], v[188:191]
    ds_write_b128 v124, v[200:203] offset:18432
    v_mfma_f32_16x16x32_bf16 v[204:207], a[236:239], v[108:111], v[204:207]
    ds_write_b128 v124, v[140:143] offset:3072
    s_nop 0
    ds_write_b128 v124, v[156:159] offset:7168
    s_nop 0
    ds_write_b128 v124, v[172:175] offset:11264
    s_nop 0
    ds_write_b128 v124, v[188:191] offset:15360
    s_nop 0
    ds_write_b128 v124, v[204:207] offset:19456
    s_waitcnt lgkmcnt(0)
    s_barrier
    ds_read_b128 v[16:19], v125 offset:0
    ds_read_b128 v[20:23], v125 offset:20480
    ds_read_b128 v[24:27], v126 offset:0
    ds_read_b128 v[28:31], v126 offset:20480
    ds_read_b128 v[32:35], v125 offset:4096
    ds_read_b128 v[36:39], v125 offset:24576
    ds_read_b128 v[40:43], v126 offset:4096
    ds_read_b128 v[44:47], v126 offset:24576
    ds_read_b128 v[48:51], v125 offset:8192
    ds_read_b128 v[52:55], v125 offset:28672
    ds_read_b128 v[56:59], v126 offset:8192
    ds_read_b128 v[60:63], v126 offset:28672
    ds_read_b128 v[64:67], v125 offset:12288
    ds_read_b128 v[68:71], v125 offset:32768
    ds_read_b128 v[72:75], v126 offset:12288
    ds_read_b128 v[76:79], v126 offset:32768
    ds_read_b128 v[80:83], v125 offset:16384
    ds_read_b128 v[84:87], v125 offset:36864
    ds_read_b128 v[88:91], v126 offset:16384
    ds_read_b128 v[92:95], v126 offset:36864
    v_lshlrev_b32 v128, 16, v228
    v_and_b32 v129, 0xffff0000, v228
    v_lshlrev_b32 v130, 16, v229
    v_and_b32 v131, 0xffff0000, v229
    v_lshlrev_b32 v132, 16, v230
    v_and_b32 v133, 0xffff0000, v230
    v_lshlrev_b32 v134, 16, v231
    v_and_b32 v135, 0xffff0000, v231
    v_lshlrev_b32 v136, 16, v232
    v_and_b32 v137, 0xffff0000, v232
    v_lshlrev_b32 v138, 16, v233
    v_and_b32 v139, 0xffff0000, v233
    v_lshlrev_b32 v140, 16, v234
    v_and_b32 v141, 0xffff0000, v234
    v_lshlrev_b32 v142, 16, v235
    v_and_b32 v143, 0xffff0000, v235
    v_lshlrev_b32 v144, 16, v236
    v_and_b32 v145, 0xffff0000, v236
    v_lshlrev_b32 v146, 16, v237
    v_and_b32 v147, 0xffff0000, v237
    s_waitcnt lgkmcnt(15)
    v_pk_add_f32 v[16:17], v[16:17], v[20:21]
    v_pk_add_f32 v[18:19], v[18:19], v[22:23]
    v_pk_add_f32 v[24:25], v[24:25], v[28:29]
    v_pk_add_f32 v[26:27], v[26:27], v[30:31]
    v_pk_add_f32 v[16:17], v[16:17], v[24:25]
    v_pk_add_f32 v[18:19], v[18:19], v[26:27]
    v_pk_fma_f32 v[16:17], v[16:17], v[208:209], v[128:129]
    v_pk_fma_f32 v[18:19], v[18:19], v[210:211], v[130:131]
    v_cvt_pk_bf16_f32 v16, v16, v17
    v_cvt_pk_bf16_f32 v17, v18, v19
    buffer_store_dwordx2 v[16:17], v122, s[76:79], 0 offen offset:0
    s_waitcnt lgkmcnt(12)
    v_pk_add_f32 v[32:33], v[32:33], v[36:37]
    v_pk_add_f32 v[34:35], v[34:35], v[38:39]
    v_pk_add_f32 v[40:41], v[40:41], v[44:45]
    v_pk_add_f32 v[42:43], v[42:43], v[46:47]
    v_pk_add_f32 v[32:33], v[32:33], v[40:41]
    v_pk_add_f32 v[34:35], v[34:35], v[42:43]
    v_pk_fma_f32 v[32:33], v[32:33], v[212:213], v[132:133]
    v_pk_fma_f32 v[34:35], v[34:35], v[214:215], v[134:135]
    v_cvt_pk_bf16_f32 v32, v32, v33
    v_cvt_pk_bf16_f32 v33, v34, v35
    buffer_store_dwordx2 v[32:33], v122, s[76:79], 0 offen offset:32
    s_waitcnt lgkmcnt(8)
    v_pk_add_f32 v[48:49], v[48:49], v[52:53]
    v_pk_add_f32 v[50:51], v[50:51], v[54:55]
    v_pk_add_f32 v[56:57], v[56:57], v[60:61]
    v_pk_add_f32 v[58:59], v[58:59], v[62:63]
    v_pk_add_f32 v[48:49], v[48:49], v[56:57]
    v_pk_add_f32 v[50:51], v[50:51], v[58:59]
    v_pk_fma_f32 v[48:49], v[48:49], v[216:217], v[136:137]
    v_pk_fma_f32 v[50:51], v[50:51], v[218:219], v[138:139]
    v_cvt_pk_bf16_f32 v48, v48, v49
    v_cvt_pk_bf16_f32 v49, v50, v51
    buffer_store_dwordx2 v[48:49], v122, s[76:79], 0 offen offset:64
    s_waitcnt lgkmcnt(4)
    v_pk_add_f32 v[64:65], v[64:65], v[68:69]
    v_pk_add_f32 v[66:67], v[66:67], v[70:71]
    v_pk_add_f32 v[72:73], v[72:73], v[76:77]
    v_pk_add_f32 v[74:75], v[74:75], v[78:79]
    v_pk_add_f32 v[64:65], v[64:65], v[72:73]
    v_pk_add_f32 v[66:67], v[66:67], v[74:75]
    v_pk_fma_f32 v[64:65], v[64:65], v[220:221], v[140:141]
    v_pk_fma_f32 v[66:67], v[66:67], v[222:223], v[142:143]
    v_cvt_pk_bf16_f32 v64, v64, v65
    v_cvt_pk_bf16_f32 v65, v66, v67
    buffer_store_dwordx2 v[64:65], v122, s[76:79], 0 offen offset:96
    s_waitcnt lgkmcnt(0)
    v_pk_add_f32 v[80:81], v[80:81], v[84:85]
    v_pk_add_f32 v[82:83], v[82:83], v[86:87]
    v_pk_add_f32 v[88:89], v[88:89], v[92:93]
    v_pk_add_f32 v[90:91], v[90:91], v[94:95]
    v_pk_add_f32 v[80:81], v[80:81], v[88:89]
    v_pk_add_f32 v[82:83], v[82:83], v[90:91]
    v_pk_fma_f32 v[80:81], v[80:81], v[224:225], v[144:145]
    v_pk_fma_f32 v[82:83], v[82:83], v[226:227], v[146:147]
    v_cvt_pk_bf16_f32 v80, v80, v81
    v_cvt_pk_bf16_f32 v81, v82, v83
    buffer_store_dwordx2 v[80:81], v122, s[76:79], 0 offen offset:128
L_k5_exit:
    s_endpgm
code_end:
.p2align 8
.type ktable,@object
ktable:
.short 1280, 1280, 1280, 1280, 1278, 1278, 1278, 1278, 1278, 1278, 1278, 1276, 1276, 1276, 1276, 1276
.short 1276, 1276, 1276, 1276, 1274, 1274, 1274, 1274, 1274, 1274, 1274, 1272, 1272, 1272, 1272, 1272
.short 1272, 1272, 1272, 1272, 1270, 1270, 1270, 1270, 1270, 1270, 1270, 1268, 1268, 1268, 1268, 1268
.short 1268, 1268, 1268, 1268, 1266, 1266, 1266, 1266, 1266, 1266, 1266, 1264, 1264, 1264, 1264, 1264
.short 1264, 1264, 1264, 1264, 1262, 1262, 1262, 1262, 1262, 1262, 1262, 1260, 1260, 1260, 1260, 1260
.short 1260, 1260, 1260, 1260, 1258, 1258, 1258, 1258, 1258, 1258, 1258, 1256, 1256, 1256, 1256, 1256
.short 1256, 1256, 1256, 1256, 1254, 1254, 1254, 1254, 1254, 1254, 1254, 1252, 1252, 1252, 1252, 1252
.short 1252, 1252, 1252, 1252, 1250, 1250, 1250, 1250, 1250, 1250, 1250, 1248, 1248, 1248, 1248, 1248
.short 1248, 1248, 1248, 1248, 1246, 1246, 1246, 1246, 1246, 1246, 1246, 1244, 1244, 1244, 1244, 1244
.short 1244, 1244, 1244, 1244, 1242, 1242, 1242, 1242, 1242, 1242, 1242, 1240, 1240, 1240, 1240, 1240
.short 1240, 1240, 1240, 1240, 1238, 1238, 1238, 1238, 1238, 1238, 1238, 1236, 1236, 1236, 1236, 1236
.short 1236, 1236, 1236, 1236, 1234, 1234, 1234, 1234, 1234, 1234, 1234, 1232, 1232, 1232, 1232, 1232
.short 1232, 1232, 1232, 1232, 1230, 1230, 1230, 1230, 1230, 1230, 1230, 1228, 1228, 1228, 1228, 1228
.short 1228, 1228, 1228, 1228, 1226, 1226, 1226, 1226, 1226, 1226, 1226, 1224, 1224, 1224, 1224, 1224
.short 1224, 1224, 1224, 1224, 1222, 1222, 1222, 1222, 1222, 1222, 1222, 1220, 1220, 1220, 1220, 1220
.short 1220, 1220, 1220, 1220, 1218, 1218, 1218, 1218, 1218, 1218, 1218, 1216, 1216, 1216, 1216, 1216
.short 1216, 1216, 1216, 1216, 1214, 1214, 1214, 1214, 1214, 1214, 1214, 1212, 1212, 1212, 1212, 1212
.short 1212, 1212, 1212, 1212, 1210, 1210, 1210, 1210, 1210, 1210, 1210, 1208, 1208, 1208, 1208, 1208
.short 1208, 1208, 1208, 1208, 1206, 1206, 1206, 1206, 1206, 1206, 1206, 1204, 1204, 1204, 1204, 1204
.short 1204, 1204, 1204, 1204, 1202, 1202, 1202, 1202, 1202, 1202, 1202, 1200, 1200, 1200, 1200, 1200
.short 1200, 1200, 1200, 1200, 1198, 1198, 1198, 1198, 1198, 1198, 1198, 1196, 1196, 1196, 1196, 1196
.short 1196, 1196, 1196, 1196, 1194, 1194, 1194, 1194, 1194, 1194, 1194, 1192, 1192, 1192, 1192, 1192
.short 1192, 1192, 1192, 1192, 1190, 1190, 1190, 1190, 1190, 1190, 1190, 1188, 1188, 1188, 1188, 1188
.short 1188, 1188, 1188, 1188, 1186, 1186, 1186, 1186, 1186, 1186, 1186, 1184, 1184, 1184, 1184, 1184
.short 1184, 1184, 1184, 1184, 1182, 1182, 1182, 1182, 1182, 1182, 1182, 1180, 1180, 1180, 1180, 1180
.short 1180, 1180, 1180, 1180, 1178, 1178, 1178, 1178, 1178, 1178, 1178, 1176, 1176, 1176, 1176, 1176
.short 1176, 1176, 1176, 1176, 1174, 1174, 1174, 1174, 1174, 1174, 1174, 1172, 1172, 1172, 1172, 1172
.short 1172, 1172, 1172, 1172, 1170, 1170, 1170, 1170, 1170, 1170, 1170, 1168, 1168, 1168, 1168, 1168
.short 1168, 1168, 1168, 1168, 1166, 1166, 1166, 1166, 1166, 1166, 1166, 1164, 1164, 1164, 1164, 1164
.short 1164, 1164, 1164, 1164, 1162, 1162, 1162, 1162, 1162, 1162, 1162, 1160, 1160, 1160, 1160, 1160
.short 1160, 1160, 1160, 1160, 1158, 1158, 1158, 1158, 1158, 1158, 1158, 1156, 1156, 1156, 1156, 1156
.short 1156, 1156, 1156, 1156, 1154, 1154, 1154, 1154, 1154, 1154, 1154, 1152, 1152, 1152, 1152, 1152
.short 1152, 1152, 1152, 1152, 1150, 1150, 1150, 1150, 1150, 1150, 1150, 1148, 1148, 1148, 1148, 1148
.short 1148, 1148, 1148, 1148, 1146, 1146, 1146, 1146, 1146, 1146, 1146, 1144, 1144, 1144, 1144, 1144
.short 1144, 1144, 1144, 1144, 1142, 1142, 1142, 1142, 1142, 1142, 1142, 1140, 1140, 1140, 1140, 1140
.short 1140, 1140, 1140, 1140, 1138, 1138, 1138, 1138, 1138, 1138, 1138, 1136, 1136, 1136, 1136, 1136
.short 1136, 1136, 1136, 1136, 1134, 1134, 1134, 1134, 1134, 1134, 1134, 1132, 1132, 1132, 1132, 1132
.short 1132, 1132, 1132, 1132, 1130, 1130, 1130, 1130, 1130, 1130, 1130, 1128, 1128, 1128, 1128, 1128
.short 1128, 1128, 1128, 1128, 1126, 1126, 1126, 1126, 1126, 1126, 1126, 1124, 1124, 1124, 1124, 1124
.short 1124, 1124, 1124, 1124, 1122, 1122, 1122, 1122, 1122, 1122, 1122, 1120, 1120, 1120, 1120, 1120
.short 1120, 1120, 1120, 1120, 1118, 1118, 1118, 1118, 1118, 1118, 1118, 1116, 1116, 1116, 1116, 1116
.short 1116, 1116, 1116, 1116, 1114, 1114, 1114, 1114, 1114, 1114, 1114, 1112, 1112, 1112, 1112, 1112
.short 1112, 1112, 1112, 1112, 1110, 1110, 1110, 1110, 1110, 1110, 1110, 1108, 1108, 1108, 1108, 1108
.short 1108, 1108, 1108, 1108, 1106, 1106, 1106, 1106, 1106, 1106, 1106, 1104, 1104, 1104, 1104, 1104
.short 1104, 1104, 1104, 1104, 1102, 1102, 1102, 1102, 1102, 1102, 1102, 1100, 1100, 1100, 1100, 1100
.short 1100, 1100, 1100, 1100, 1098, 1098, 1098, 1098, 1098, 1098, 1098, 1096, 1096, 1096, 1096, 1096
.short 1096, 1096, 1096, 1096, 1094, 1094, 1094, 1094, 1094, 1094, 1094, 1092, 1092, 1092, 1092, 1092
.short 1092, 1092, 1092, 1092, 1090, 1090, 1090, 1090, 1090, 1090, 1090, 1088, 1088, 1088, 1088, 1088
.short 1088, 1088, 1088, 1088, 1086, 1086, 1086, 1086, 1086, 1086, 1086, 1084, 1084, 1084, 1084, 1084
.short 1084, 1084, 1084, 1084, 1082, 1082, 1082, 1082, 1082, 1082, 1082, 1080, 1080, 1080, 1080, 1080
.short 1080, 1080, 1080, 1080, 1078, 1078, 1078, 1078, 1078, 1078, 1078, 1076, 1076, 1076, 1076, 1076
.short 1076, 1076, 1076, 1076, 1074, 1074, 1074, 1074, 1074, 1074, 1074, 1072, 1072, 1072, 1072, 1072
.short 1072, 1072, 1072, 1072, 1070, 1070, 1070, 1070, 1070, 1070, 1070, 1068, 1068, 1068, 1068, 1068
.short 1068, 1068, 1068, 1068, 1066, 1066, 1066, 1066, 1066, 1066, 1066, 1064, 1064, 1064, 1064, 1064
.short 1064, 1064, 1064, 1064, 1062, 1062, 1062, 1062, 1062, 1062, 1062, 1060, 1060, 1060, 1060, 1060
.short 1060, 1060, 1060, 1060, 1058, 1058, 1058, 1058, 1058, 1058, 1058, 1056, 1056, 1056, 1056, 1056
.short 1056, 1056, 1056, 1056, 1054, 1054, 1054, 1054, 1054, 1054, 1054, 1052, 1052, 1052, 1052, 1052
.short 1052, 1052, 1052, 1052, 1050, 1050, 1050, 1050, 1050, 1050, 1050, 1048, 1048, 1048, 1048, 1048
.short 1048, 1048, 1048, 1048, 1046, 1046, 1046, 1046, 1046, 1046, 1046, 1044, 1044, 1044, 1044, 1044
.short 1044, 1044, 1044, 1044, 1042, 1042, 1042, 1042, 1042, 1042, 1042, 1040, 1040, 1040, 1040, 1040
.short 1040, 1040, 1040, 1040, 1038, 1038, 1038, 1038, 1038, 1038, 1038, 1036, 1036, 1036, 1036, 1036
.short 1036, 1036, 1036, 1036, 1034, 1034, 1034, 1034, 1034, 1034, 1034, 1032, 1032, 1032, 1032, 1032
.short 1032, 1032, 1032, 1032, 1030, 1030, 1030, 1030, 1030, 1030, 1030, 1028, 1028, 1028, 1028, 1028
.short 1028, 1028, 1028, 1028, 1026, 1026, 1026, 1026, 1026, 1026, 1026, 1024, 1024, 1024, 1024, 1024
.short 1024, 1024, 1022, 1022, 1022, 958, 958, 958, 958, 958, 1020, 1020, 1020, 956, 956, 956
.short 956, 956, 1018, 1018, 1018, 954, 954, 954, 954, 954, 1016, 1016, 1016, 952, 952, 952
.short 952, 952, 1014, 1014, 1014, 950, 950, 950, 950, 950, 1012, 1012, 1012, 948, 948, 948
.short 948, 948, 1010, 1010, 1010, 946, 946, 946, 946, 946, 1008, 1008, 1008, 944, 944, 944
.short 944, 944, 1006, 1006, 1006, 942, 942, 942, 942, 942, 1004, 1004, 1004, 940, 940, 940
.short 940, 940, 1002, 1002, 1002, 938, 938, 938, 938, 938, 1000, 1000, 1000, 936, 936, 936
.short 936, 936, 998, 998, 998, 934, 934, 934, 934, 934, 996, 996, 996, 932, 932, 932
.short 932, 932, 994, 994, 994, 930, 930, 930, 930, 930, 992, 992, 992, 928, 928, 928
.short 928, 928, 990, 990, 990, 926, 926, 926, 926, 926, 988, 988, 988, 924, 924, 924
.short 924, 924, 986, 986, 986, 922, 922, 922, 922, 922, 984, 984, 984, 920, 920, 920
.short 920, 920, 982, 982, 982, 918, 918, 918, 918, 918, 980, 980, 980, 916, 916, 916
.short 916, 916, 978, 978, 978, 914, 914, 914, 914, 914, 976, 976, 976, 912, 912, 912
.short 912, 912, 974, 974, 974, 910, 910, 910, 910, 910, 972, 972, 972, 908, 908, 908
.short 908, 908, 970, 970, 970, 906, 906, 906, 906, 906, 968, 968, 968, 904, 904, 904
.short 904, 904, 966, 966, 966, 902, 902, 902, 902, 902, 964, 964, 964, 900, 900, 900
.short 900, 900, 962, 962, 962, 898, 898, 898, 898, 898, 960, 960, 960, 896, 896, 896
.short 896, 896, 894, 894, 894, 830, 830, 830, 830, 830, 892, 892, 892, 828, 828, 828
.short 828, 828, 890, 890, 890, 826, 826, 826, 826, 826, 888, 888, 888, 824, 824, 824
.short 824, 824, 886, 886, 886, 822, 822, 822, 822, 822, 884, 884, 884, 820, 820, 820
.short 820, 820, 882, 882, 882, 818, 818, 818, 818, 818, 880, 880, 880, 816, 816, 816
.short 816, 816, 878, 878, 878, 814, 814, 814, 814, 814, 876, 876, 876, 812, 812, 812
.short 812, 812, 874, 874, 874, 810, 810, 810, 810, 810, 872, 872, 872, 808, 808, 808
.short 808, 808, 870, 870, 870, 806, 806, 806, 806, 806, 868, 868, 868, 804, 804, 804
.short 804, 804, 866, 866, 866, 802, 802, 802, 802, 802, 864, 864, 864, 800, 800, 800
.short 800, 800, 862, 862, 862, 798, 798, 798, 798, 798, 860, 860, 860, 796, 796, 796
.short 796, 796, 858, 858, 858, 794, 794, 794, 794, 794, 856, 856, 856, 792, 792, 792
.short 792, 792, 854, 854, 854, 790, 790, 790, 790, 790, 852, 852, 852, 788, 788, 788
.short 788, 788, 850, 850, 850, 786, 786, 786, 786, 786, 848, 848, 848, 784, 784, 784
.short 784, 784, 846, 846, 846, 782, 782, 782, 782, 782, 844, 844, 844, 780, 780, 780
.short 780, 780, 842, 842, 842, 778, 778, 778, 778, 778, 840, 840, 840, 776, 776, 776
.short 776, 776, 838, 838, 838, 774, 774, 774, 774, 774, 836, 836, 836, 772, 772, 772
.short 772, 772, 834, 834, 834, 770, 770, 770, 770, 770, 832, 832, 832, 768, 768, 768
.short 768, 766, 702, 702, 702, 638, 574, 574, 574, 764, 700, 700, 700, 636, 572, 572
.short 572, 762, 698, 698, 698, 634, 570, 570, 570, 760, 696, 696, 696, 632, 568, 568
.short 568, 758, 694, 694, 694, 630, 566, 566, 566, 756, 692, 692, 692, 628, 564, 564
.short 564, 754, 690, 690, 690, 626, 562, 562, 562, 752, 688, 688, 688, 624, 560, 560
.short 560, 750, 686, 686, 686, 622, 558, 558, 558, 748, 684, 684, 684, 620, 556, 556
.short 556, 746, 682, 682, 682, 618, 554, 554, 554, 744, 680, 680, 680, 616, 552, 552
.short 552, 742, 678, 678, 678, 614, 550, 550, 550, 740, 676, 676, 676, 612, 548, 548
.short 548, 738, 674, 674, 674, 610, 546, 546, 546, 736, 672, 672, 672, 608, 544, 544
.short 544, 734, 670, 670, 670, 606, 542, 542, 542, 732, 668, 668, 668, 604, 540, 540
.short 540, 730, 666, 666, 666, 602, 538, 538, 538, 728, 664, 664, 664, 600, 536, 536
.short 536, 726, 662, 662, 662, 598, 534, 534, 534, 724, 660, 660, 660, 596, 532, 532
.short 532, 722, 658, 658, 658, 594, 530, 530, 530, 720, 656, 656, 656, 592, 528, 528
.short 528, 718, 654, 654, 654, 590, 526, 526, 526, 716, 652, 652, 652, 588, 524, 524
.short 524, 714, 650, 650, 650, 586, 522, 522, 522, 712, 648, 648, 648, 584, 520, 520
.short 520, 710, 646, 646, 646, 582, 518, 518, 518, 708, 644, 644, 644, 580, 516, 516
.short 516, 706, 642, 642, 642, 578, 514, 514, 514, 704, 640, 640, 640, 576, 512, 512
.short 510, 446, 382, 318, 254, 190, 126, 62, 508, 444, 380, 316, 252, 188, 124, 60
.short 506, 442, 378, 314, 250, 186, 122, 58, 504, 440, 376, 312, 248, 184, 120, 56
.short 502, 438, 374, 310, 246, 182, 118, 54, 500, 436, 372, 308, 244, 180, 116, 52
.short 498, 434, 370, 306, 242, 178, 114, 50, 496, 432, 368, 304, 240, 176, 112, 48
.short 494, 430, 366, 302, 238, 174, 110, 46, 492, 428, 364, 300, 236, 172, 108, 44
.short 490, 426, 362, 298, 234, 170, 106, 42, 488, 424, 360, 296, 232, 168, 104, 40
.short 486, 422, 358, 294, 230, 166, 102, 38, 484, 420, 356, 292, 228, 164, 100, 36
.short 482, 418, 354, 290, 226, 162, 98, 34, 480, 416, 352, 288, 224, 160, 96, 32
.short 478, 414, 350, 286, 222, 158, 94, 30, 476, 412, 348, 284, 220, 156, 92, 28
.short 474, 410, 346, 282, 218, 154, 90, 26, 472, 408, 344, 280, 216, 152, 88, 24
.short 470, 406, 342, 278, 214, 150, 86, 22, 468, 404, 340, 276, 212, 148, 84, 20
.short 466, 402, 338, 274, 210, 146, 82, 18, 464, 400, 336, 272, 208, 144, 80, 16
.short 462, 398, 334, 270, 206, 142, 78, 14, 460, 396, 332, 268, 204, 140, 76, 12
.short 458, 394, 330, 266, 202, 138, 74, 10, 456, 392, 328, 264, 200, 136, 72, 8
.short 454, 390, 326, 262, 198, 134, 70, 6, 452, 388, 324, 260, 196, 132, 68, 4
.short 450, 386, 322, 258, 194, 130, 66, 2, 448, 384, 320, 256, 192, 128, 64, 0
.short 1344, 1344, 1344, 1344, 1344, 1344, 1344, 1344, 1344, 1344, 1344, 1344, 1344, 1344, 1344, 1344
.size ktable, 4128
.section .rodata,"a"
.p2align 6
.amdhsa_kernel prep_kernel
  .amdhsa_next_free_vgpr 112
  .amdhsa_next_free_sgpr 36
  .amdhsa_accum_offset 112
  .amdhsa_group_segment_fixed_size 0
  .amdhsa_kernarg_size 128
  .amdhsa_user_sgpr_count 2
  .amdhsa_user_sgpr_kernarg_segment_ptr 1
  .amdhsa_system_sgpr_workgroup_id_x 1
  .amdhsa_float_denorm_mode_32 3
.end_amdhsa_kernel
.p2align 6
.amdhsa_kernel conv_kernel
  .amdhsa_next_free_vgpr 128
  .amdhsa_next_free_sgpr 57
  .amdhsa_accum_offset 128
  .amdhsa_group_segment_fixed_size 0
  .amdhsa_kernarg_size 128
  .amdhsa_user_sgpr_count 2
  .amdhsa_user_sgpr_kernarg_segment_ptr 1
  .amdhsa_system_sgpr_workgroup_id_x 1
  .amdhsa_float_denorm_mode_32 3
.end_amdhsa_kernel
.p2align 6
.amdhsa_kernel ffn_kernel
  .amdhsa_next_free_vgpr 484
  .amdhsa_next_free_sgpr 86
  .amdhsa_accum_offset 244
  .amdhsa_group_segment_fixed_size 0
  .amdhsa_kernarg_size 128
  .amdhsa_user_sgpr_count 2
  .amdhsa_user_sgpr_kernarg_segment_ptr 1
  .amdhsa_system_sgpr_workgroup_id_x 1
  .amdhsa_float_denorm_mode_32 3
.end_amdhsa_kernel
```
